```python
import torch

def _softmax(x, axis=-1):
    return torch.softmax(x, dim=axis)
def _gelu(x):
    return torch.nn.functional.gelu(x, approximate="tanh")
def _silu(x):
    return torch.nn.functional.silu(x)
def _sigmoid(x):
    return torch.sigmoid(x)
def _layernorm(x, axis=-1, eps=1e-5):
    m = x.mean(dim=axis, keepdim=True)
    v = x.var(dim=axis, keepdim=True, unbiased=False)
    return (x - m) / torch.sqrt(v + eps)
def _scatter_add(tgt, idx, src, axis=0):
    return tgt.clone().index_add_(axis, idx, src)
def _segment_sum(src, seg, n):
    out = torch.zeros((n,) + src.shape[1:], dtype=src.dtype)
    return out.index_add_(0, seg, src)
def _pad(x, pw):
    flat = tuple(v for pair in reversed(pw) for v in pair)
    return torch.nn.functional.pad(x, flat)

kernel_name = 'standalone__edge_featured_mpnn_egc__graph'

def setup_inputs():

    _w = (lambda a: (lambda t: t.to(torch.bfloat16) if t.is_floating_point() else t)(torch.as_tensor(a)))
    N, deg, D, De = 25000, 16, 128, max(16, 1)
    E = N * deg
    return {
        "x": _w((lambda *s: torch.randn(*s, dtype=torch.bfloat16) * 0.2)(N, D)),
        "e_attr": _w((lambda *s: torch.randn(*s, dtype=torch.bfloat16) * 0.2)(E, De)),
        "src": _w((lambda lo, hi, *s: torch.randint(lo, hi, s))(0, N, E).to(torch.int64)),
        "dst": _w((lambda lo, hi, *s: torch.randint(lo, hi, s))(0, N, E).to(torch.int64)),
        "u_w": _w((lambda *s: torch.randn(*s, dtype=torch.bfloat16) * 0.05)(D, D)),
        "v_w": _w((lambda *s: torch.randn(*s, dtype=torch.bfloat16) * 0.05)(D, D)),
        "g_w": _w((lambda *s: torch.randn(*s, dtype=torch.bfloat16) * 0.2)(2 * D + De, D)),
    }

def reference(x, e_attr, src, dst, u_w, v_w, g_w):
    N, D = x.shape
    g_in = torch.concatenate([x[dst], x[src], e_attr], axis=-1)
    eta = _sigmoid(g_in @ g_w)
    hv = x @ v_w
    msg = eta * hv[src]
    agg = _segment_sum(msg, dst, N)
    return _silu(x @ u_w + agg)
```

```asm
; @launch grid=(256,1,1) block=(512,1,1) lds=163840
.amdgcn_target "amdgcn-amd-amdhsa--gfx950"
.text
.globl standalone__edge_featured_mpnn_egc__graph_kernel
.p2align 8
.type standalone__edge_featured_mpnn_egc__graph_kernel,@function
standalone__edge_featured_mpnn_egc__graph_kernel:
    s_cmp_ge_u32 s2, 256
    s_cbranch_scc1 K_END
    s_load_dwordx2 s[18:19], s[0:1], 72
    s_load_dwordx4 s[8:11], s[0:1], 16
    s_load_dwordx4 s[4:7], s[0:1], 0
    s_load_dwordx4 s[12:15], s[0:1], 32
    s_load_dwordx2 s[16:17], s[0:1], 48
    s_load_dwordx2 s[32:33], s[0:1], 56
    s_mov_b32 s3, s2
    s_and_b32 s64, s2, 7
    s_lshl_b32 s64, s64, 5
    s_lshr_b32 s2, s2, 3
    s_add_u32 s2, s2, s64
    v_mov_b32 v16, v0
    v_lshrrev_b32 v20, 6, v0
    s_mov_b32 s74, s3
    v_readfirstlane_b32 s52, v20
    s_mov_b32 s80, 0
    s_mov_b32 s81, 0
    s_mov_b32 s68, 0
    s_mov_b32 s58, 12
    s_mov_b32 s60, 512
    s_mov_b32 s63, 3216550459
    s_lshr_b32 s76, s52, 1
    s_mov_b32 s53, s76
    s_and_b32 s54, s52, 1
    s_mul_i32 s55, s52, 12288
    s_add_u32 s55, s55, 53248
    s_lshl_b32 s64, s76, 3
    s_lshr_b32 s66, 1227954432, s64
    s_and_b32 s66, s66, 0xff
    s_lshr_b32 s77, 421009433, s64
    s_and_b32 s77, s77, 0xff
    s_mul_i32 s78, s2, 98
    s_add_u32 s78, s78, s66
    s_lshl_b32 s61, s54, 8
    s_add_u32 s62, s61, 128
    s_cmp_ge_u32 s52, 4
    s_cselect_b32 s69, -1, 1
    s_waitcnt lgkmcnt(0)
K_SORT:
    s_mov_b32 s20, s10
    s_and_b32 s21, s11, 0xffff
    s_mov_b32 s22, 1600000
    s_mov_b32 s23, 0x20000
    s_mov_b32 s48, s8
    s_and_b32 s49, s9, 0xffff
    s_mov_b32 s50, 1600000
    s_mov_b32 s51, 0x20000
    s_mul_i32 s64, s74, 6256
    v_lshl_add_u32 v168, v16, 4, s64
    v_mov_b32 v169, 2147483392
    v_cmp_gt_u32 vcc, 391, v16
    s_nop 1
    v_cndmask_b32 v168, v169, v168, vcc
    buffer_load_dwordx4 v[128:131], v168, s[20:23], 0 offen
    buffer_load_dwordx4 v[132:135], v168, s[48:51], 0 offen
    v_cmp_gt_u32 vcc, 1600000, v168
    s_nop 0
    s_mov_b64 s[0:1], vcc
    v_lshlrev_b32 v169, 2, v16
    v_mov_b32 v170, 0
    ds_write_b32 v169, v170 offset:6464
    s_barrier
    s_cmp_eq_u32 s80, 0
    s_cbranch_scc1 S_FIRST
    s_waitcnt vmcnt(0)
    s_branch S_GO
S_FIRST:
    v_mbcnt_lo_u32_b32 v20, -1, 0
    v_mbcnt_hi_u32_b32 v20, -1, v20
    s_lshr_b32 s64, s3, 3
    s_cmp_lg_u32 s52, 5
    s_cbranch_scc1 K_WP5
    s_mov_b32 s20, s16
    s_and_b32 s21, s17, 0xffff
    s_mov_b32 s22, 69632
    s_mov_b32 s23, 0x20000
    s_mul_i32 s66, s64, 17
    v_add_lshl_u32 v21, v20, s66, 7
    s_mov_b64 exec, 131071
    buffer_load_dword v223, v21, s[20:23], 0 offen
    s_mov_b64 exec, -1
K_WP5:
    s_cmp_lg_u32 s52, 6
    s_cbranch_scc1 K_WP6
    s_mov_b32 s20, s14
    s_and_b32 s21, s15, 0xffff
    s_mov_b32 s22, 32768
    s_mov_b32 s23, 0x20000
    s_mul_i32 s66, s64, 8
    v_add_lshl_u32 v21, v20, s66, 7
    s_mov_b64 exec, 255
    buffer_load_dword v223, v21, s[20:23], 0 offen
    s_mov_b64 exec, -1
K_WP6:
    s_cmp_lg_u32 s52, 7
    s_cbranch_scc1 K_WP7
    s_mov_b32 s20, s12
    s_and_b32 s21, s13, 0xffff
    s_mov_b32 s22, 32768
    s_mov_b32 s23, 0x20000
    s_mul_i32 s66, s64, 8
    v_add_lshl_u32 v21, v20, s66, 7
    s_mov_b64 exec, 255
    buffer_load_dword v223, v21, s[20:23], 0 offen
    s_mov_b64 exec, -1
K_WP7:
    s_mov_b32 s24, s4
    s_and_b32 s25, s5, 0xffff
    s_mov_b32 s26, 6400000
    s_mov_b32 s27, 0x20000
    v_mov_b32 v31, 2147483392
    v_mbcnt_lo_u32_b32 v21, -1, 0
    v_mbcnt_hi_u32_b32 v21, -1, v21
    v_lshrrev_b32 v20, 4, v21
    v_and_b32 v21, 15, v21
    s_lshl_b32 s64, s54, 4
    s_add_u32 s65, s64, s78
    v_add_lshl_u32 v22, v20, s65, 8
    s_sub_u32 s65, s77, s64
    s_lshl_b32 s64, s52, 12
    s_add_u32 m0, s64, 118784
    v_add_u32 v23, 0, v20
    v_xor_b32 v23, v23, v21
    v_lshl_add_u32 v23, v23, 4, v22
    buffer_load_dwordx4 v23, s[24:27], 0 offen offset:0 lds
    v_add_u32 v23, 4, v20
    v_xor_b32 v23, v23, v21
    v_lshl_add_u32 v23, v23, 4, v22
    buffer_load_dwordx4 v23, s[24:27], 0 offen offset:1024 lds
    v_add_u32 v23, 8, v20
    v_cmp_le_u32 vcc, s65, v23
    v_xor_b32 v23, v23, v21
    v_lshl_add_u32 v23, v23, 4, v22
    v_cndmask_b32 v23, v23, v31, vcc
    buffer_load_dwordx4 v23, s[24:27], 0 offen offset:2048 lds
    v_add_u32 v23, 12, v20
    v_cmp_le_u32 vcc, s65, v23
    v_xor_b32 v23, v23, v21
    v_lshl_add_u32 v23, v23, 4, v22
    v_cndmask_b32 v23, v23, v31, vcc
    buffer_load_dwordx4 v23, s[24:27], 0 offen offset:3072 lds
    v_mbcnt_lo_u32_b32 v21, -1, 0
    v_mbcnt_hi_u32_b32 v21, -1, v21
    v_lshrrev_b32 v20, 4, v21
    v_and_b32 v21, 15, v21
    v_lshlrev_b32 v14, 2, v20
    v_xor_b32 v14, v14, v21
    v_lshlrev_b32 v14, 4, v14
    v_lshl_add_u32 v14, v20, 8, v14
    s_lshl_b32 s64, s52, 12
    v_add_u32 v14, s64, v14
    s_mov_b32 s28, s6
    s_and_b32 s29, s7, 0xffff
    s_mov_b32 s30, 12800000
    s_mov_b32 s31, 0x20000
    s_and_b32 s33, s33, 0xffff
    s_mov_b32 s34, 6400000
    s_mov_b32 s35, 0x20000
    s_add_u32 s44, s18, 25165824
    s_addc_u32 s45, s19, 0
    s_and_b32 s45, s45, 0xffff
    s_mov_b32 s46, 524288
    s_mov_b32 s47, 0x20000
    s_add_u32 s40, s18, 12845056
    s_addc_u32 s41, s19, 0
    s_and_b32 s41, s41, 0xffff
    s_mov_b32 s42, 3211264
    s_mov_b32 s43, 0x20000
    s_add_u32 s4, s18, 16531456
    s_addc_u32 s5, s19, 0
    s_load_dword s79, s[4:5], 0
    s_mov_b32 s36, s18
    s_and_b32 s37, s19, 0xffff
    s_mov_b32 s38, 12800000
    s_mov_b32 s39, 0x20000
    v_cmp_gt_u32 vcc, 256, v16
    s_nop 0
    s_mov_b64 exec, vcc
    s_cbranch_execz K_L1
    v_and_b32 v21, 15, v16
    v_bfe_u32 v22, v16, 4, 1
    s_mov_b32 s64, 19
    v_mad_u32_u24 v21, v22, s64, v21
    v_bfe_u32 v22, v16, 5, 1
    s_mov_b32 s64, 37
    v_mad_u32_u24 v21, v22, s64, v21
    v_bfe_u32 v22, v16, 6, 1
    s_mov_b32 s64, 86
    v_mad_u32_u24 v21, v22, s64, v21
    v_bfe_u32 v22, v16, 7, 1
    s_mov_b32 s64, 169
    v_mad_u32_u24 v21, v22, s64, v21
    v_lshlrev_b32 v21, 4, v21
    v_lshl_or_b32 v22, v16, 15, v16
    v_and_b32 v24, 65537, v22
    v_mul_u32_u24 v24, 15360, v24
    v_and_b32 v25, 262148, v22
    v_mul_u32_u24 v25, 3840, v25
    v_and_b32 v26, 1048592, v22
    v_mul_u32_u24 v26, 960, v26
    v_and_b32 v27, 4194368, v22
    v_mul_u32_u24 v27, 240, v27
    ds_write_b128 v21, v[24:27] offset:0
    s_nop 0
    v_lshrrev_b32 v21, 2, v16
    v_and_b32 v22, 3, v16
    v_lshrrev_b32 v28, 1, v21
    v_cmp_eq_u32 vcc, v28, v22
    v_and_b32 v21, 1, v21
    v_lshlrev_b32 v21, 4, v21
    v_mov_b32 v22, 15360
    v_lshlrev_b32 v21, v21, v22
    v_cndmask_b32 v21, 0, v21, vcc
    v_lshlrev_b32 v22, 2, v16
    v_mov_b32 v28, 0
    v_cmp_gt_u32 vcc, 144, v16
    s_nop 0
    s_mov_b64 exec, vcc
    s_cbranch_execz K_L1
    ds_write_b32 v22, v28 offset:5376
    v_cmp_gt_u32 vcc, 36, v16
    s_nop 0
    s_mov_b64 exec, vcc
    s_cbranch_execz K_L1
    ds_write_b32 v22, v21 offset:5232
K_L1:
    s_mov_b64 exec, -1
    v_mbcnt_lo_u32_b32 v23, -1, 0
    v_mbcnt_hi_u32_b32 v23, -1, v23
    v_and_b32 v20, 31, v23
    v_lshrrev_b32 v21, 5, v23
    v_bfe_u32 v22, v23, 1, 3
    v_xor_b32 v22, v22, v21
    v_lshlrev_b32 v22, 4, v22
    v_lshl_add_u32 v22, v20, 7, v22
    v_add_u32 v1, s55, v22
    v_xor_b32 v2, 32, v1
    v_xor_b32 v3, 64, v1
    v_xor_b32 v4, 96, v1
    v_lshrrev_b32 v22, 4, v23
    v_and_b32 v5, 7, v23
    v_xor_b32 v5, v5, v22
    v_lshlrev_b32 v5, 4, v5
    v_xor_b32 v6, 64, v5
    v_bfe_u32 v22, v20, 3, 1
    v_and_b32 v12, 3, v20
    v_lshl_add_u32 v22, v22, 2, v12
    v_lshlrev_b32 v22, 4, v22
    v_lshrrev_b32 v12, 4, v20
    v_cmp_eq_u32 vcc, v12, v21
    v_mov_b32 v21, 128
    s_nop 0
    v_cndmask_b32 v22, v21, v22, vcc
    v_and_b32 v20, 4, v20
    v_cmp_eq_u32 vcc, 0, v20
    s_nop 1
    v_cndmask_b32 v12, v21, v22, vcc
    v_cndmask_b32 v13, v22, v21, vcc
    v_mbcnt_lo_u32_b32 v23, -1, 0
    v_mbcnt_hi_u32_b32 v23, -1, v23
    v_bfe_u32 v20, v23, 2, 2
    v_lshrrev_b32 v21, 5, v23
    v_lshl_add_u32 v21, v21, 3, v20
    v_lshlrev_b32 v18, 8, v21
    s_lshl_b32 s64, s54, 1
    v_xor_b32 v20, s64, v20
    v_lshl_add_u32 v18, v20, 6, v18
    v_and_b32 v21, 1, v23
    v_lshl_add_u32 v18, v21, 5, v18
    v_bfe_u32 v21, v23, 4, 1
    v_lshl_add_u32 v18, v21, 4, v18
    v_bfe_u32 v21, v23, 1, 1
    v_lshl_add_u32 v18, v21, 3, v18
    v_add_u32 v18, 53248, v18
    v_xor_b32 v19, 64, v18
    s_waitcnt lgkmcnt(0)
    s_add_u32 s79, s79, 1
    s_add_u32 s4, s18, 16515072
    s_addc_u32 s5, s19, 0
    s_and_b32 s5, s5, 0xffff
    s_mov_b32 s6, 16512
    s_mov_b32 s7, 0x20000
S_GO:
    s_waitcnt lgkmcnt(0)
    s_barrier
    s_mov_b32 s64, 10700
    s_mov_b32 s65, 1227954432
    s_waitcnt vmcnt(5)
    v_mul_u32_u24 v136, s64, v128
    v_lshrrev_b32 v136, 20, v136
    v_mul_u32_u24 v169, 98, v136
    v_sub_u32 v128, v128, v169
    v_lshlrev_b32 v136, 2, v136
    v_mul_u32_u24 v137, s64, v129
    v_lshrrev_b32 v137, 20, v137
    v_mul_u32_u24 v169, 98, v137
    v_sub_u32 v129, v129, v169
    v_lshlrev_b32 v137, 2, v137
    v_mul_u32_u24 v138, s64, v130
    v_lshrrev_b32 v138, 20, v138
    v_mul_u32_u24 v169, 98, v138
    v_sub_u32 v130, v130, v169
    v_lshlrev_b32 v138, 2, v138
    v_mul_u32_u24 v139, s64, v131
    v_lshrrev_b32 v139, 20, v139
    v_mul_u32_u24 v169, 98, v139
    v_sub_u32 v131, v131, v169
    v_lshlrev_b32 v139, 2, v139
    v_mov_b32 v170, 1
    s_mov_b64 exec, s[0:1]
    s_cbranch_execz S_NOH
    ds_add_rtn_u32 v140, v136, v170 offset:6464
    ds_add_rtn_u32 v141, v137, v170 offset:6464
    ds_add_rtn_u32 v142, v138, v170 offset:6464
    ds_add_rtn_u32 v143, v139, v170 offset:6464
S_NOH:
    s_mov_b64 exec, -1
    s_waitcnt vmcnt(4)
    s_cmp_lg_u32 s80, 0
    s_cbranch_scc1 S_H1
    s_mov_b32 s20, s14
    s_and_b32 s21, s15, 0xffff
    s_mov_b32 s22, 32768
    s_mov_b32 s23, 0x20000
    s_lshl_b32 s64, s52, 12
    s_mov_b32 s66, 0
    s_add_u32 m0, s64, 86016
    s_nop 0
    buffer_load_dwordx4 v14, s[20:23], s66 offen offset:0 lds
    buffer_load_dwordx4 v14, s[20:23], s66 offen offset:1024 lds
    buffer_load_dwordx4 v14, s[20:23], s66 offen offset:2048 lds
    buffer_load_dwordx4 v14, s[20:23], s66 offen offset:3072 lds
S_H1:
    s_waitcnt lgkmcnt(0)
    s_barrier
    v_mbcnt_lo_u32_b32 v169, -1, 0
    v_mbcnt_hi_u32_b32 v169, -1, v169
    v_lshlrev_b32 v169, 4, v169
    ds_read_b128 v[152:155], v169 offset:6464
    v_mul_u32_u24 v176, 337, v128
    v_lshrrev_b32 v176, 13, v176
    v_lshlrev_b32 v177, 3, v176
    v_bfe_u32 v177, s65, v177, 8
    v_sub_u32 v177, v128, v177
    v_lshl_or_b32 v144, v177, 15, v132
    v_mul_u32_u24 v177, 1342, v132
    v_lshrrev_b32 v177, 20, v177
    v_lshl_add_u32 v177, v176, 5, v177
    v_lshl_or_b32 v144, v177, 25, v144
    v_lshlrev_b32 v145, 3, v168
    v_add_u32 v145, 0, v145
    v_mul_u32_u24 v176, 337, v129
    v_lshrrev_b32 v176, 13, v176
    v_lshlrev_b32 v177, 3, v176
    v_bfe_u32 v177, s65, v177, 8
    s_waitcnt lgkmcnt(0)
    v_add_u32 v156, v152, v153
    v_add_u32 v157, v156, v154
    v_add_u32 v158, v157, v155
    v_mov_b32 v159, v158
    v_sub_u32 v177, v129, v177
    v_lshl_or_b32 v146, v177, 15, v133
    v_add_u32_dpp v159, v159, v159 row_shr:1 row_mask:0xf bank_mask:0xf bound_ctrl:1
    v_mul_u32_u24 v177, 1342, v133
    v_lshrrev_b32 v177, 20, v177
    v_add_u32_dpp v159, v159, v159 row_shr:2 row_mask:0xf bank_mask:0xf bound_ctrl:1
    v_lshl_add_u32 v177, v176, 5, v177
    v_lshl_or_b32 v146, v177, 25, v146
    v_add_u32_dpp v159, v159, v159 row_shr:4 row_mask:0xf bank_mask:0xf bound_ctrl:1
    v_lshlrev_b32 v147, 3, v168
    v_add_u32 v147, 32, v147
    v_add_u32_dpp v159, v159, v159 row_shr:8 row_mask:0xf bank_mask:0xf bound_ctrl:1
    v_mul_u32_u24 v176, 337, v130
    v_lshrrev_b32 v176, 13, v176
    v_add_u32_dpp v159, v159, v159 row_bcast:15 row_mask:0xa bank_mask:0xf
    v_lshlrev_b32 v177, 3, v176
    v_bfe_u32 v177, s65, v177, 8
    v_add_u32_dpp v159, v159, v159 row_bcast:31 row_mask:0xc bank_mask:0xf
    v_sub_u32 v160, v159, v158
    v_add_u32 v161, v160, v152
    v_add_u32 v162, v160, v156
    v_add_u32 v163, v160, v157
    ds_write_b128 v169, v[160:163] offset:7488
    ds_read_b32 v172, v136 offset:7488
    ds_read_b32 v173, v137 offset:7488
    ds_read_b32 v174, v138 offset:7488
    ds_read_b32 v175, v139 offset:7488
    v_sub_u32 v177, v130, v177
    v_lshl_or_b32 v148, v177, 15, v134
    v_mul_u32_u24 v177, 1342, v134
    v_lshrrev_b32 v177, 20, v177
    v_lshl_add_u32 v177, v176, 5, v177
    v_lshl_or_b32 v148, v177, 25, v148
    v_lshlrev_b32 v149, 3, v168
    v_add_u32 v149, 64, v149
    v_mul_u32_u24 v176, 337, v131
    v_lshrrev_b32 v176, 13, v176
    v_lshlrev_b32 v177, 3, v176
    v_bfe_u32 v177, s65, v177, 8
    v_sub_u32 v177, v131, v177
    v_lshl_or_b32 v150, v177, 15, v135
    v_mul_u32_u24 v177, 1342, v135
    v_lshrrev_b32 v177, 20, v177
    v_lshl_add_u32 v177, v176, 5, v177
    v_lshl_or_b32 v150, v177, 25, v150
    v_lshlrev_b32 v151, 3, v168
    v_add_u32 v151, 96, v151
    s_cmp_eq_u32 s80, 0
    s_cbranch_scc1 S_ROW
    s_lshl_b32 s64, s2, 2
    v_mov_b32 v169, s64
    ds_read_b32 v152, v169 offset:6464
    ds_read_b32 v153, v169 offset:7488
    s_lshl_b32 s64, s74, 2
    v_mov_b32 v169, s64
    s_waitcnt lgkmcnt(0)
    v_lshl_or_b32 v152, v152, 16, v153
    ds_write_b32 v169, v152 offset:11072
    s_branch S_NOC
S_ROW:
    v_lshrrev_b32 v169, 1, v169
    ds_read_b64 v[152:153], v169 offset:6464
    ds_read_b64 v[154:155], v169 offset:7488
    ds_read_b64 v[156:157], v169 offset:6976
    ds_read_b64 v[158:159], v169 offset:8000
    s_waitcnt lgkmcnt(0)
    v_mov_b32 v180, s79
    v_lshl_or_b32 v181, v152, 16, v154
    v_mov_b32 v182, s79
    v_lshl_or_b32 v183, v153, 16, v155
    v_mov_b32 v184, s79
    v_lshl_or_b32 v185, v156, 16, v158
    v_mov_b32 v186, s79
    v_lshl_or_b32 v187, v157, 16, v159
S_NOC:
    s_waitcnt lgkmcnt(0)
    v_add_lshl_u32 v172, v172, v140, 3
    v_add_lshl_u32 v173, v173, v141, 3
    v_add_lshl_u32 v174, v174, v142, 3
    v_add_lshl_u32 v175, v175, v143, 3
    s_cmp_eq_u32 s80, 0
    s_cbranch_scc1 S_PUB
    s_mul_i32 s64, s74, 12544
    s_lshl_b32 s65, s2, 2
    v_cmp_eq_u32 vcc, s65, v136
    v_add_u32 v172, s64, v172
    s_and_b64 exec, vcc, s[0:1]
    s_cbranch_execz S_P0
    buffer_store_dwordx2 v[144:145], v172, s[40:43], 0 offen sc1
S_P0:
    s_mov_b64 exec, -1
    v_cmp_eq_u32 vcc, s65, v137
    v_add_u32 v173, s64, v173
    s_and_b64 exec, vcc, s[0:1]
    s_cbranch_execz S_P1
    buffer_store_dwordx2 v[146:147], v173, s[40:43], 0 offen sc1
S_P1:
    s_mov_b64 exec, -1
    v_cmp_eq_u32 vcc, s65, v138
    v_add_u32 v174, s64, v174
    s_and_b64 exec, vcc, s[0:1]
    s_cbranch_execz S_P2
    buffer_store_dwordx2 v[148:149], v174, s[40:43], 0 offen sc1
S_P2:
    s_mov_b64 exec, -1
    v_cmp_eq_u32 vcc, s65, v139
    v_add_u32 v175, s64, v175
    s_and_b64 exec, vcc, s[0:1]
    s_cbranch_execz S_P3
    buffer_store_dwordx2 v[150:151], v175, s[40:43], 0 offen sc1
S_P3:
    s_mov_b64 exec, -1
    s_waitcnt vmcnt(0)
    s_barrier
    s_branch K_HELP1N
S_PUB:
    s_mov_b64 exec, s[0:1]
    s_cbranch_execz S_NOS
    ds_write_b64 v172, v[144:145] offset:35648
    ds_write_b64 v173, v[146:147] offset:35648
    ds_write_b64 v174, v[148:149] offset:35648
    ds_write_b64 v175, v[150:151] offset:35648
S_NOS:
    s_mov_b64 exec, -1
    s_mov_b32 s20, s16
    s_and_b32 s21, s17, 0xffff
    s_mov_b32 s22, 69632
    s_mov_b32 s23, 0x20000
    s_lshl_b32 s64, s52, 12
    s_mov_b32 s66, 32768
    s_add_u32 m0, s64, 53248
    s_nop 0
    buffer_load_dwordx4 v14, s[20:23], s66 offen offset:0 lds
    buffer_load_dwordx4 v14, s[20:23], s66 offen offset:1024 lds
    buffer_load_dwordx4 v14, s[20:23], s66 offen offset:2048 lds
    buffer_load_dwordx4 v14, s[20:23], s66 offen offset:3072 lds
    s_cmp_ge_u32 s52, 4
    s_cbranch_scc1 K_NOC
    s_mul_i32 s64, s52, 3072
    s_sub_u32 s66, 65536, s64
    s_lshl_b32 s64, s52, 10
    s_add_u32 m0, s64, 151552
    s_nop 0
    buffer_load_dwordx4 v14, s[20:23], s66 offen lds
K_NOC:
    s_waitcnt lgkmcnt(0)
    s_barrier
    v_lshlrev_b32 v169, 4, v16
    ds_read_b128 v[128:131], v169 offset:35648
    ds_read_b128 v[132:135], v169 offset:43840
    s_mul_i32 s64, s74, 12544
    v_add_u32 v169, s64, v169
    v_add_u32 v170, 8192, v169
    v_mov_b32 v176, 2147483392
    v_cmp_gt_u32 vcc, 272, v16
    s_nop 1
    v_cndmask_b32 v170, v176, v170, vcc
    s_waitcnt lgkmcnt(1)
    buffer_store_dwordx4 v[128:131], v169, s[40:43], 0 offen sc1
    s_waitcnt lgkmcnt(0)
    buffer_store_dwordx4 v[132:135], v170, s[40:43], 0 offen sc1
    s_lshr_b32 s64, s2, 5
    s_mov_b64 s[72:73], 0
    v_lshrrev_b32 v176, 7, v136
    v_bfe_u32 v177, v144, 25, 5
    v_cmp_eq_u32 vcc, s64, v176
    v_cmp_gt_u32 s[70:71], 25, v177
    s_nop 0
    s_and_b64 vcc, vcc, s[70:71]
    s_or_b64 s[72:73], s[72:73], vcc
    v_lshrrev_b32 v176, 7, v137
    v_bfe_u32 v177, v146, 25, 5
    v_cmp_eq_u32 vcc, s64, v176
    v_cmp_gt_u32 s[70:71], 25, v177
    s_nop 0
    s_and_b64 vcc, vcc, s[70:71]
    s_or_b64 s[72:73], s[72:73], vcc
    v_lshrrev_b32 v176, 7, v138
    v_bfe_u32 v177, v148, 25, 5
    v_cmp_eq_u32 vcc, s64, v176
    v_cmp_gt_u32 s[70:71], 25, v177
    s_nop 0
    s_and_b64 vcc, vcc, s[70:71]
    s_or_b64 s[72:73], s[72:73], vcc
    v_lshrrev_b32 v176, 7, v139
    v_bfe_u32 v177, v150, 25, 5
    v_cmp_eq_u32 vcc, s64, v176
    v_cmp_gt_u32 s[70:71], 25, v177
    s_nop 0
    s_and_b64 vcc, vcc, s[70:71]
    s_or_b64 s[72:73], s[72:73], vcc
    s_and_b64 s[72:73], s[72:73], s[0:1]
    s_waitcnt vmcnt(2)
    s_barrier
    ds_read_b128 v[248:251], v12 offset:5232
    ds_read_b128 v[252:255], v13 offset:5232
    v_mbcnt_lo_u32_b32 v20, -1, 0
    v_mbcnt_hi_u32_b32 v20, -1, v20
    v_and_b32 v21, 15, v20
    v_lshrrev_b32 v22, 5, v20
    v_xor_b32 v21, v21, v22
    v_lshlrev_b32 v21, 4, v21
    v_and_b32 v20, 31, v20
    v_lshl_add_u32 v22, v20, 8, v21
    s_lshl_b32 s64, s76, 13
    s_add_u32 s64, s64, 118784
    v_add_u32 v22, s64, v22
    v_xor_b32 v21, 0, v22
    ds_read_b128 v[96:99], v21
    v_xor_b32 v21, 32, v22
    ds_read_b128 v[100:103], v21
    v_xor_b32 v21, 64, v22
    ds_read_b128 v[104:107], v21
    v_xor_b32 v21, 96, v22
    ds_read_b128 v[108:111], v21
    v_xor_b32 v21, 128, v22
    ds_read_b128 v[112:115], v21
    v_xor_b32 v21, 160, v22
    ds_read_b128 v[116:119], v21
    v_xor_b32 v21, 192, v22
    ds_read_b128 v[120:123], v21
    v_xor_b32 v21, 224, v22
    ds_read_b128 v[124:127], v21
    s_waitcnt vmcnt(0)
    v_mov_b32 v20, 5912
    v_mov_b32 v21, 1
    s_mov_b64 exec, 1
    ds_add_rtn_u32 v22, v20, v21
    s_mov_b64 exec, -1
    s_waitcnt lgkmcnt(0)
    v_readfirstlane_b32 s64, v22
    s_nop 0
    s_cmp_lg_u32 s64, 7
    s_cbranch_scc1 K_NOS1
    v_mbcnt_lo_u32_b32 v20, -1, 0
    v_mbcnt_hi_u32_b32 v20, -1, v20
    s_lshl_b32 s64, s3, 11
    v_lshl_add_u32 v20, v20, 4, s64
    buffer_store_dwordx4 v[180:183], v20, s[44:47], 0 offen offset:0 sc1
    buffer_store_dwordx4 v[184:187], v20, s[44:47], 0 offen offset:1024 sc1
K_NOS1:
    s_barrier
    s_mov_b64 exec, s[72:73]
    s_cbranch_execz K_NOPF
    buffer_load_dword v222, v145, s[28:31], 0 offen
K_NOPF:
    s_mov_b64 exec, -1
    v_add_u32 v20, 98304, v18
    ds_read_b64_tr_b16 v[240:241], v20 offset:0
    ds_read_b64_tr_b16 v[242:243], v20 offset:1024
    v_add_u32 v21, 98304, v19
    ds_read_b64_tr_b16 v[244:245], v21 offset:0
    ds_read_b64_tr_b16 v[246:247], v21 offset:1024
    s_waitcnt lgkmcnt(0)
    v_lshlrev_b32 v20, 16, v240
    v_and_b32 v21, 0xffff0000, v240
    v_mul_f32 v20, s63, v20
    v_mul_f32 v21, s63, v21
    v_cvt_pk_bf16_f32 v240, v20, v21
    v_lshlrev_b32 v20, 16, v241
    v_and_b32 v21, 0xffff0000, v241
    v_mul_f32 v20, s63, v20
    v_mul_f32 v21, s63, v21
    v_cvt_pk_bf16_f32 v241, v20, v21
    v_lshlrev_b32 v20, 16, v242
    v_and_b32 v21, 0xffff0000, v242
    v_mul_f32 v20, s63, v20
    v_mul_f32 v21, s63, v21
    v_cvt_pk_bf16_f32 v242, v20, v21
    v_lshlrev_b32 v20, 16, v243
    v_and_b32 v21, 0xffff0000, v243
    v_mul_f32 v20, s63, v20
    v_mul_f32 v21, s63, v21
    v_cvt_pk_bf16_f32 v243, v20, v21
    v_lshlrev_b32 v20, 16, v244
    v_and_b32 v21, 0xffff0000, v244
    v_mul_f32 v20, s63, v20
    v_mul_f32 v21, s63, v21
    v_cvt_pk_bf16_f32 v244, v20, v21
    v_lshlrev_b32 v20, 16, v245
    v_and_b32 v21, 0xffff0000, v245
    v_mul_f32 v20, s63, v20
    v_mul_f32 v21, s63, v21
    v_cvt_pk_bf16_f32 v245, v20, v21
    v_lshlrev_b32 v20, 16, v246
    v_and_b32 v21, 0xffff0000, v246
    v_mul_f32 v20, s63, v20
    v_mul_f32 v21, s63, v21
    v_cvt_pk_bf16_f32 v246, v20, v21
    v_lshlrev_b32 v20, 16, v247
    v_and_b32 v21, 0xffff0000, v247
    v_mul_f32 v20, s63, v20
    v_mul_f32 v21, s63, v21
    v_cvt_pk_bf16_f32 v247, v20, v21
    s_lshl_b32 s66, s52, 12
    s_add_u32 s66, s66, 11136
    v_mbcnt_lo_u32_b32 v20, -1, 0
    v_mbcnt_hi_u32_b32 v20, -1, v20
    v_and_b32 v21, 31, v20
    v_lshrrev_b32 v22, 5, v20
    v_lshlrev_b32 v22, 1, v22
    v_and_b32 v24, 7, v20
    v_xor_b32 v24, v24, v22
    v_lshlrev_b32 v24, 4, v24
    v_lshl_add_u32 v24, v21, 7, v24
    v_add_u32 v24, s66, v24
    v_xor_b32 v25, 16, v24
    v_xor_b32 v26, 64, v24
    v_xor_b32 v27, 80, v24
    v_lshl_add_u32 v28, v20, 4, s66
    v_lshrrev_b32 v21, 3, v20
    v_and_b32 v22, 7, v20
    v_xor_b32 v22, v22, v21
    v_add_lshl_u32 v8, v21, s78, 9
    v_lshl_add_u32 v8, v22, 4, v8
    v_add_u32 v8, s61, v8
    v_add_u32 v9, 4096, v8
    v_add_u32 v10, 8192, v8
    s_sub_u32 s64, s77, 24
    s_lshl_b32 s64, s64, 3
    v_cmp_gt_u32 vcc, s64, v20
    v_add_u32 v11, 12288, v8
    v_mov_b32 v31, 2147483392
    v_cndmask_b32 v11, v31, v11, vcc
    v_mov_b32 v29, 0xff7f0000
    ds_read_b64_tr_b16 v[48:49], v18 offset:0
    ds_read_b64_tr_b16 v[50:51], v18 offset:1024
    ds_read_b64_tr_b16 v[52:53], v18 offset:32768
    ds_read_b64_tr_b16 v[54:55], v18 offset:33792
    ds_read_b64_tr_b16 v[56:57], v18 offset:4096
    ds_read_b64_tr_b16 v[58:59], v18 offset:5120
    ds_read_b64_tr_b16 v[60:61], v18 offset:36864
    ds_read_b64_tr_b16 v[62:63], v18 offset:37888
    s_waitcnt lgkmcnt(4)
    v_mfma_f32_32x32x16_bf16 v[64:79], v[48:51], v[96:99], 0
    v_mfma_f32_32x32x16_bf16 v[80:95], v[52:55], v[96:99], 0
    ds_read_b64_tr_b16 v[48:49], v18 offset:8192
    ds_read_b64_tr_b16 v[50:51], v18 offset:9216
    ds_read_b64_tr_b16 v[52:53], v18 offset:40960
    ds_read_b64_tr_b16 v[54:55], v18 offset:41984
    s_waitcnt lgkmcnt(4)
    v_mfma_f32_32x32x16_bf16 v[64:79], v[56:59], v[100:103], v[64:79]
    v_mfma_f32_32x32x16_bf16 v[80:95], v[60:63], v[100:103], v[80:95]
    ds_read_b64_tr_b16 v[56:57], v18 offset:12288
    ds_read_b64_tr_b16 v[58:59], v18 offset:13312
    ds_read_b64_tr_b16 v[60:61], v18 offset:45056
    ds_read_b64_tr_b16 v[62:63], v18 offset:46080
    s_waitcnt lgkmcnt(4)
    v_mfma_f32_32x32x16_bf16 v[64:79], v[48:51], v[104:107], v[64:79]
    v_mfma_f32_32x32x16_bf16 v[80:95], v[52:55], v[104:107], v[80:95]
    ds_read_b64_tr_b16 v[48:49], v18 offset:16384
    ds_read_b64_tr_b16 v[50:51], v18 offset:17408
    ds_read_b64_tr_b16 v[52:53], v18 offset:49152
    ds_read_b64_tr_b16 v[54:55], v18 offset:50176
    s_waitcnt lgkmcnt(4)
    v_mfma_f32_32x32x16_bf16 v[64:79], v[56:59], v[108:111], v[64:79]
    v_mfma_f32_32x32x16_bf16 v[80:95], v[60:63], v[108:111], v[80:95]
    ds_read_b64_tr_b16 v[56:57], v18 offset:20480
    ds_read_b64_tr_b16 v[58:59], v18 offset:21504
    ds_read_b64_tr_b16 v[60:61], v18 offset:53248
    ds_read_b64_tr_b16 v[62:63], v18 offset:54272
    s_waitcnt lgkmcnt(4)
    v_mfma_f32_32x32x16_bf16 v[64:79], v[48:51], v[112:115], v[64:79]
    v_mfma_f32_32x32x16_bf16 v[80:95], v[52:55], v[112:115], v[80:95]
    ds_read_b64_tr_b16 v[48:49], v18 offset:24576
    ds_read_b64_tr_b16 v[50:51], v18 offset:25600
    ds_read_b64_tr_b16 v[52:53], v18 offset:57344
    ds_read_b64_tr_b16 v[54:55], v18 offset:58368
    s_waitcnt lgkmcnt(4)
    v_mfma_f32_32x32x16_bf16 v[64:79], v[56:59], v[116:119], v[64:79]
    v_mfma_f32_32x32x16_bf16 v[80:95], v[60:63], v[116:119], v[80:95]
    ds_read_b64_tr_b16 v[56:57], v18 offset:28672
    ds_read_b64_tr_b16 v[58:59], v18 offset:29696
    ds_read_b64_tr_b16 v[60:61], v18 offset:61440
    ds_read_b64_tr_b16 v[62:63], v18 offset:62464
    s_waitcnt lgkmcnt(4)
    v_mfma_f32_32x32x16_bf16 v[64:79], v[48:51], v[120:123], v[64:79]
    v_mfma_f32_32x32x16_bf16 v[80:95], v[52:55], v[120:123], v[80:95]
    s_waitcnt lgkmcnt(0)
    v_mfma_f32_32x32x16_bf16 v[64:79], v[56:59], v[124:127], v[64:79]
    v_mfma_f32_32x32x16_bf16 v[80:95], v[60:63], v[124:127], v[80:95]
    s_lshl_b32 s64, s2, 3
    v_lshrrev_b32 v46, 1, v16
    v_lshl_add_u32 v46, v46, 11, s64
    buffer_load_dwordx2 v[44:45], v46, s[44:47], 0 offen
    s_mov_b32 s65, 0x7f7f0000
    s_nop 5
    v_mul_f32 v64, s63, v64
    v_mul_f32 v65, s63, v65
    v_mul_f32 v66, s63, v66
    v_mul_f32 v67, s63, v67
    v_mul_f32 v68, s63, v68
    v_mul_f32 v69, s63, v69
    v_mul_f32 v70, s63, v70
    v_mul_f32 v71, s63, v71
    v_mul_f32 v72, s63, v72
    v_mul_f32 v73, s63, v73
    v_mul_f32 v74, s63, v74
    v_mul_f32 v75, s63, v75
    v_mul_f32 v76, s63, v76
    v_mul_f32 v77, s63, v77
    v_mul_f32 v78, s63, v78
    v_mul_f32 v79, s63, v79
    v_rcp_f32 v80, v80
    v_rcp_f32 v81, v81
    v_rcp_f32 v82, v82
    v_rcp_f32 v83, v83
    v_rcp_f32 v84, v84
    v_rcp_f32 v85, v85
    v_rcp_f32 v86, v86
    v_rcp_f32 v87, v87
    v_rcp_f32 v88, v88
    v_rcp_f32 v89, v89
    v_rcp_f32 v90, v90
    v_rcp_f32 v91, v91
    v_rcp_f32 v92, v92
    v_rcp_f32 v93, v93
    v_rcp_f32 v94, v94
    v_rcp_f32 v95, v95
    v_cvt_pk_f16_f32 v224, v64, v65
    v_cvt_pk_f16_f32 v225, v66, v67
    v_cvt_pk_f16_f32 v226, v68, v69
    v_cvt_pk_f16_f32 v227, v70, v71
    v_cvt_pk_f16_f32 v228, v72, v73
    v_cvt_pk_f16_f32 v229, v74, v75
    v_cvt_pk_f16_f32 v230, v76, v77
    v_cvt_pk_f16_f32 v231, v78, v79
    v_med3_f32 v80, v80, v29, s65
    v_med3_f32 v81, v81, v29, s65
    v_med3_f32 v82, v82, v29, s65
    v_med3_f32 v83, v83, v29, s65
    v_med3_f32 v84, v84, v29, s65
    v_med3_f32 v85, v85, v29, s65
    v_med3_f32 v86, v86, v29, s65
    v_med3_f32 v87, v87, v29, s65
    v_med3_f32 v88, v88, v29, s65
    v_med3_f32 v89, v89, v29, s65
    v_med3_f32 v90, v90, v29, s65
    v_med3_f32 v91, v91, v29, s65
    v_med3_f32 v92, v92, v29, s65
    v_med3_f32 v93, v93, v29, s65
    v_med3_f32 v94, v94, v29, s65
    v_med3_f32 v95, v95, v29, s65
    v_cvt_pk_bf16_f32 v232, v80, v81
    v_cvt_pk_bf16_f32 v233, v82, v83
    v_cvt_pk_bf16_f32 v234, v84, v85
    v_cvt_pk_bf16_f32 v235, v86, v87
    v_cvt_pk_bf16_f32 v236, v88, v89
    v_cvt_pk_bf16_f32 v237, v90, v91
    v_cvt_pk_bf16_f32 v238, v92, v93
    v_cvt_pk_bf16_f32 v239, v94, v95
    ds_write_b128 v24, v[224:227]
    ds_write_b128 v25, v[228:231]
    ds_write_b128 v26, v[232:235]
    ds_write_b128 v27, v[236:239]
    ds_read_b128 v[192:195], v28 offset:0
    ds_read_b128 v[196:199], v28 offset:1024
    ds_read_b128 v[200:203], v28 offset:2048
    ds_read_b128 v[204:207], v28 offset:3072
    ds_read_b64_tr_b16 v[48:49], v19 offset:0
    ds_read_b64_tr_b16 v[50:51], v19 offset:1024
    ds_read_b64_tr_b16 v[52:53], v19 offset:32768
    ds_read_b64_tr_b16 v[54:55], v19 offset:33792
    ds_read_b64_tr_b16 v[56:57], v19 offset:4096
    ds_read_b64_tr_b16 v[58:59], v19 offset:5120
    ds_read_b64_tr_b16 v[60:61], v19 offset:36864
    ds_read_b64_tr_b16 v[62:63], v19 offset:37888
    s_waitcnt lgkmcnt(4)
    v_mfma_f32_32x32x16_bf16 v[64:79], v[48:51], v[96:99], 0
    v_mfma_f32_32x32x16_bf16 v[80:95], v[52:55], v[96:99], 0
    ds_read_b64_tr_b16 v[48:49], v19 offset:8192
    ds_read_b64_tr_b16 v[50:51], v19 offset:9216
    ds_read_b64_tr_b16 v[52:53], v19 offset:40960
    ds_read_b64_tr_b16 v[54:55], v19 offset:41984
    s_waitcnt vmcnt(0)
    s_mov_b32 s66, 0
K_CHK:
    v_cmp_ne_u32 vcc, s79, v44
    s_nop 0
    s_mov_b64 exec, vcc
    s_cbranch_execz K_CELLS
    s_cmp_ge_u32 s66, 4000
    s_cbranch_scc1 K_CFAIL
    s_sleep 4
    buffer_load_dwordx2 v[44:45], v46, s[44:47], 0 offen sc1
    s_add_u32 s66, s66, 1
    s_waitcnt vmcnt(0)
    s_branch K_CHK
K_CFAIL:
    v_mov_b32 v45, 0
    v_mov_b32 v20, 5904
    v_mov_b32 v21, 1
    ds_write_b32 v20, v21
K_CELLS:
    s_mov_b64 exec, -1
    v_lshrrev_b32 v20, 16, v45
    v_add_u32 v21, 1, v20
    v_lshrrev_b32 v21, 1, v21
    v_sub_u32 v20, v20, v21
    v_and_b32 v0, 0xffff, v45
    v_and_b32 v22, 1, v16
    v_cmp_eq_u32 vcc, 1, v22
    v_mad_u32_u24 v0, v22, v21, v0
    s_nop 0
    v_cndmask_b32 v20, v21, v20, vcc
    v_lshl_or_b32 v0, v20, 16, v0
    v_lshrrev_b32 v22, 16, v0
    v_min_u32 v17, s58, v22
    v_cmp_lt_u32 vcc, v17, v22
    s_nop 0
    s_cmp_lg_u64 vcc, 0
    s_cselect_b32 s59, 1, 0
    v_and_b32 v20, 0xffff, v0
    v_lshrrev_b32 v21, 1, v16
    v_mul_u32_u24 v21, 12544, v21
    v_lshl_add_u32 v20, v20, 3, v21
    v_cmp_lt_u32 vcc, 0, v17
    s_nop 0
    s_mov_b64 exec, vcc
    s_cbranch_execz K_RL0
    buffer_load_dwordx4 v[128:131], v20, s[40:43], 0 offen offset:0
    v_cmp_lt_u32 vcc, 2, v17
    s_nop 0
    s_mov_b64 exec, vcc
    s_cbranch_execz K_RL0
    buffer_load_dwordx4 v[132:135], v20, s[40:43], 0 offen offset:16
    v_cmp_lt_u32 vcc, 4, v17
    s_nop 0
    s_mov_b64 exec, vcc
    s_cbranch_execz K_RL0
    buffer_load_dwordx4 v[136:139], v20, s[40:43], 0 offen offset:32
    v_cmp_lt_u32 vcc, 6, v17
    s_nop 0
    s_mov_b64 exec, vcc
    s_cbranch_execz K_RL0
    buffer_load_dwordx4 v[140:143], v20, s[40:43], 0 offen offset:48
    v_cmp_lt_u32 vcc, 8, v17
    s_nop 0
    s_mov_b64 exec, vcc
    s_cbranch_execz K_RL0
    buffer_load_dwordx4 v[144:147], v20, s[40:43], 0 offen offset:64
    v_cmp_lt_u32 vcc, 10, v17
    s_nop 0
    s_mov_b64 exec, vcc
    s_cbranch_execz K_RL0
    buffer_load_dwordx4 v[148:151], v20, s[40:43], 0 offen offset:80
K_RL0:
    s_mov_b64 exec, -1
    buffer_store_dwordx4 v[192:195], v8, s[36:39], 0 offen offset:0 sc1
    buffer_store_dwordx4 v[196:199], v9, s[36:39], 0 offen offset:0 sc1
    buffer_store_dwordx4 v[200:203], v10, s[36:39], 0 offen offset:0 sc1
    buffer_store_dwordx4 v[204:207], v11, s[36:39], 0 offen offset:0 sc1
    s_waitcnt lgkmcnt(5)
    v_mfma_f32_32x32x16_bf16 v[64:79], v[56:59], v[100:103], v[64:79]
    v_mfma_f32_32x32x16_bf16 v[80:95], v[60:63], v[100:103], v[80:95]
    ds_read_b64_tr_b16 v[56:57], v19 offset:12288
    ds_read_b64_tr_b16 v[58:59], v19 offset:13312
    ds_read_b64_tr_b16 v[60:61], v19 offset:45056
    ds_read_b64_tr_b16 v[62:63], v19 offset:46080
    s_waitcnt lgkmcnt(5)
    v_mfma_f32_32x32x16_bf16 v[64:79], v[48:51], v[104:107], v[64:79]
    v_mfma_f32_32x32x16_bf16 v[80:95], v[52:55], v[104:107], v[80:95]
    ds_read_b64_tr_b16 v[48:49], v19 offset:16384
    ds_read_b64_tr_b16 v[50:51], v19 offset:17408
    ds_read_b64_tr_b16 v[52:53], v19 offset:49152
    ds_read_b64_tr_b16 v[54:55], v19 offset:50176
    s_waitcnt lgkmcnt(4)
    v_mfma_f32_32x32x16_bf16 v[64:79], v[56:59], v[108:111], v[64:79]
    v_mfma_f32_32x32x16_bf16 v[80:95], v[60:63], v[108:111], v[80:95]
    ds_read_b64_tr_b16 v[56:57], v19 offset:20480
    ds_read_b64_tr_b16 v[58:59], v19 offset:21504
    ds_read_b64_tr_b16 v[60:61], v19 offset:53248
    ds_read_b64_tr_b16 v[62:63], v19 offset:54272
    s_waitcnt lgkmcnt(4)
    v_mfma_f32_32x32x16_bf16 v[64:79], v[48:51], v[112:115], v[64:79]
    v_mfma_f32_32x32x16_bf16 v[80:95], v[52:55], v[112:115], v[80:95]
    ds_read_b64_tr_b16 v[48:49], v19 offset:24576
    ds_read_b64_tr_b16 v[50:51], v19 offset:25600
    ds_read_b64_tr_b16 v[52:53], v19 offset:57344
    ds_read_b64_tr_b16 v[54:55], v19 offset:58368
    s_waitcnt lgkmcnt(4)
    v_mfma_f32_32x32x16_bf16 v[64:79], v[56:59], v[116:119], v[64:79]
    v_mfma_f32_32x32x16_bf16 v[80:95], v[60:63], v[116:119], v[80:95]
    ds_read_b64_tr_b16 v[56:57], v19 offset:28672
    ds_read_b64_tr_b16 v[58:59], v19 offset:29696
    ds_read_b64_tr_b16 v[60:61], v19 offset:61440
    ds_read_b64_tr_b16 v[62:63], v19 offset:62464
    s_waitcnt lgkmcnt(4)
    v_mfma_f32_32x32x16_bf16 v[64:79], v[48:51], v[120:123], v[64:79]
    v_mfma_f32_32x32x16_bf16 v[80:95], v[52:55], v[120:123], v[80:95]
    s_waitcnt lgkmcnt(0)
    v_mfma_f32_32x32x16_bf16 v[64:79], v[56:59], v[124:127], v[64:79]
    v_mfma_f32_32x32x16_bf16 v[80:95], v[60:63], v[124:127], v[80:95]
    s_mov_b32 s65, 0x7f7f0000
    s_nop 9
    v_mul_f32 v64, s63, v64
    v_mul_f32 v65, s63, v65
    v_mul_f32 v66, s63, v66
    v_mul_f32 v67, s63, v67
    v_mul_f32 v68, s63, v68
    v_mul_f32 v69, s63, v69
    v_mul_f32 v70, s63, v70
    v_mul_f32 v71, s63, v71
    v_mul_f32 v72, s63, v72
    v_mul_f32 v73, s63, v73
    v_mul_f32 v74, s63, v74
    v_mul_f32 v75, s63, v75
    v_mul_f32 v76, s63, v76
    v_mul_f32 v77, s63, v77
    v_mul_f32 v78, s63, v78
    v_mul_f32 v79, s63, v79
    v_rcp_f32 v80, v80
    v_rcp_f32 v81, v81
    v_rcp_f32 v82, v82
    v_rcp_f32 v83, v83
    v_rcp_f32 v84, v84
    v_rcp_f32 v85, v85
    v_rcp_f32 v86, v86
    v_rcp_f32 v87, v87
    v_rcp_f32 v88, v88
    v_rcp_f32 v89, v89
    v_rcp_f32 v90, v90
    v_rcp_f32 v91, v91
    v_rcp_f32 v92, v92
    v_rcp_f32 v93, v93
    v_rcp_f32 v94, v94
    v_rcp_f32 v95, v95
    v_cvt_pk_f16_f32 v224, v64, v65
    v_cvt_pk_f16_f32 v225, v66, v67
    v_cvt_pk_f16_f32 v226, v68, v69
    v_cvt_pk_f16_f32 v227, v70, v71
    v_cvt_pk_f16_f32 v228, v72, v73
    v_cvt_pk_f16_f32 v229, v74, v75
    v_cvt_pk_f16_f32 v230, v76, v77
    v_cvt_pk_f16_f32 v231, v78, v79
    v_med3_f32 v80, v80, v29, s65
    v_med3_f32 v81, v81, v29, s65
    v_med3_f32 v82, v82, v29, s65
    v_med3_f32 v83, v83, v29, s65
    v_med3_f32 v84, v84, v29, s65
    v_med3_f32 v85, v85, v29, s65
    v_med3_f32 v86, v86, v29, s65
    v_med3_f32 v87, v87, v29, s65
    v_med3_f32 v88, v88, v29, s65
    v_med3_f32 v89, v89, v29, s65
    v_med3_f32 v90, v90, v29, s65
    v_med3_f32 v91, v91, v29, s65
    v_med3_f32 v92, v92, v29, s65
    v_med3_f32 v93, v93, v29, s65
    v_med3_f32 v94, v94, v29, s65
    v_med3_f32 v95, v95, v29, s65
    v_cvt_pk_bf16_f32 v232, v80, v81
    v_cvt_pk_bf16_f32 v233, v82, v83
    v_cvt_pk_bf16_f32 v234, v84, v85
    v_cvt_pk_bf16_f32 v235, v86, v87
    v_cvt_pk_bf16_f32 v236, v88, v89
    v_cvt_pk_bf16_f32 v237, v90, v91
    v_cvt_pk_bf16_f32 v238, v92, v93
    v_cvt_pk_bf16_f32 v239, v94, v95
    ds_write_b128 v24, v[224:227]
    ds_write_b128 v25, v[228:231]
    ds_write_b128 v26, v[232:235]
    ds_write_b128 v27, v[236:239]
    ds_read_b128 v[64:67], v28 offset:0
    ds_read_b128 v[68:71], v28 offset:1024
    ds_read_b128 v[72:75], v28 offset:2048
    ds_read_b128 v[76:79], v28 offset:3072
    s_waitcnt vmcnt(4)
    v_mov_b32 v22, 8
    s_cmp_eq_u32 s59, 0
    s_cbranch_scc1 A_NM
    v_mov_b32 v20, 5888
    ds_write_b32 v20, v22
A_NM:
    v_cmp_lt_u32 vcc, 0, v17
    v_lshrrev_b32 v20, 23, v128
    s_mov_b64 exec, vcc
    s_cbranch_execz A_BD
    ds_add_rtn_u32 v152, v20, v22 offset:5376
    v_cmp_lt_u32 vcc, 1, v17
    v_lshrrev_b32 v21, 23, v130
    s_mov_b64 exec, vcc
    s_cbranch_execz A_BD
    ds_add_rtn_u32 v153, v21, v22 offset:5376
    v_cmp_lt_u32 vcc, 2, v17
    v_lshrrev_b32 v20, 23, v132
    s_mov_b64 exec, vcc
    s_cbranch_execz A_BD
    ds_add_rtn_u32 v154, v20, v22 offset:5376
    v_cmp_lt_u32 vcc, 3, v17
    v_lshrrev_b32 v21, 23, v134
    s_mov_b64 exec, vcc
    s_cbranch_execz A_BD
    ds_add_rtn_u32 v155, v21, v22 offset:5376
    v_cmp_lt_u32 vcc, 4, v17
    v_lshrrev_b32 v20, 23, v136
    s_mov_b64 exec, vcc
    s_cbranch_execz A_BD
    ds_add_rtn_u32 v156, v20, v22 offset:5376
    v_cmp_lt_u32 vcc, 5, v17
    v_lshrrev_b32 v21, 23, v138
    s_mov_b64 exec, vcc
    s_cbranch_execz A_BD
    ds_add_rtn_u32 v157, v21, v22 offset:5376
    v_cmp_lt_u32 vcc, 6, v17
    v_lshrrev_b32 v20, 23, v140
    s_mov_b64 exec, vcc
    s_cbranch_execz A_BD
    ds_add_rtn_u32 v158, v20, v22 offset:5376
    v_cmp_lt_u32 vcc, 7, v17
    v_lshrrev_b32 v21, 23, v142
    s_mov_b64 exec, vcc
    s_cbranch_execz A_BD
    ds_add_rtn_u32 v159, v21, v22 offset:5376
    v_cmp_lt_u32 vcc, 8, v17
    v_lshrrev_b32 v20, 23, v144
    s_mov_b64 exec, vcc
    s_cbranch_execz A_BD
    ds_add_rtn_u32 v160, v20, v22 offset:5376
    v_cmp_lt_u32 vcc, 9, v17
    v_lshrrev_b32 v21, 23, v146
    s_mov_b64 exec, vcc
    s_cbranch_execz A_BD
    ds_add_rtn_u32 v161, v21, v22 offset:5376
    v_cmp_lt_u32 vcc, 10, v17
    v_lshrrev_b32 v20, 23, v148
    s_mov_b64 exec, vcc
    s_cbranch_execz A_BD
    ds_add_rtn_u32 v162, v20, v22 offset:5376
    v_cmp_lt_u32 vcc, 11, v17
    v_lshrrev_b32 v21, 23, v150
    s_mov_b64 exec, vcc
    s_cbranch_execz A_BD
    ds_add_rtn_u32 v163, v21, v22 offset:5376
A_BD:
    s_mov_b64 exec, -1
    v_bfe_u32 v20, v128, 25, 5
    v_cmp_gt_u32 vcc, 25, v20
    v_cmp_lt_u32 s[0:1], 0, v17
    s_nop 0
    s_and_b64 vcc, vcc, s[0:1]
    s_and_b32 vcc_lo, vcc_lo, 0x55555555
    s_and_b32 vcc_hi, vcc_hi, 0x55555555
    s_mov_b64 exec, vcc
    s_cbranch_execz A_PF0
    buffer_load_dword v47, v129, s[28:31], 0 offen
A_PF0:
    s_mov_b64 exec, -1
    s_waitcnt lgkmcnt(0)
    buffer_store_dwordx4 v[64:67], v8, s[36:39], 0 offen offset:128 sc1
    buffer_store_dwordx4 v[68:71], v9, s[36:39], 0 offen offset:128 sc1
    buffer_store_dwordx4 v[72:75], v10, s[36:39], 0 offen offset:128 sc1
    buffer_store_dwordx4 v[76:79], v11, s[36:39], 0 offen offset:128 sc1
    s_branch K_COUNTED
K_BUILD:
    v_mov_b32 v22, 8
    s_cmp_eq_u32 s59, 0
    s_cbranch_scc1 B_NM
    v_mov_b32 v20, 5888
    ds_write_b32 v20, v22
B_NM:
    v_cmp_lt_u32 vcc, 0, v17
    v_lshrrev_b32 v20, 23, v128
    s_mov_b64 exec, vcc
    s_cbranch_execz B_BD
    ds_add_rtn_u32 v152, v20, v22 offset:5376
    v_cmp_lt_u32 vcc, 1, v17
    v_lshrrev_b32 v21, 23, v130
    s_mov_b64 exec, vcc
    s_cbranch_execz B_BD
    ds_add_rtn_u32 v153, v21, v22 offset:5376
    v_cmp_lt_u32 vcc, 2, v17
    v_lshrrev_b32 v20, 23, v132
    s_mov_b64 exec, vcc
    s_cbranch_execz B_BD
    ds_add_rtn_u32 v154, v20, v22 offset:5376
    v_cmp_lt_u32 vcc, 3, v17
    v_lshrrev_b32 v21, 23, v134
    s_mov_b64 exec, vcc
    s_cbranch_execz B_BD
    ds_add_rtn_u32 v155, v21, v22 offset:5376
    v_cmp_lt_u32 vcc, 4, v17
    v_lshrrev_b32 v20, 23, v136
    s_mov_b64 exec, vcc
    s_cbranch_execz B_BD
    ds_add_rtn_u32 v156, v20, v22 offset:5376
    v_cmp_lt_u32 vcc, 5, v17
    v_lshrrev_b32 v21, 23, v138
    s_mov_b64 exec, vcc
    s_cbranch_execz B_BD
    ds_add_rtn_u32 v157, v21, v22 offset:5376
    v_cmp_lt_u32 vcc, 6, v17
    v_lshrrev_b32 v20, 23, v140
    s_mov_b64 exec, vcc
    s_cbranch_execz B_BD
    ds_add_rtn_u32 v158, v20, v22 offset:5376
    v_cmp_lt_u32 vcc, 7, v17
    v_lshrrev_b32 v21, 23, v142
    s_mov_b64 exec, vcc
    s_cbranch_execz B_BD
    ds_add_rtn_u32 v159, v21, v22 offset:5376
    v_cmp_lt_u32 vcc, 8, v17
    v_lshrrev_b32 v20, 23, v144
    s_mov_b64 exec, vcc
    s_cbranch_execz B_BD
    ds_add_rtn_u32 v160, v20, v22 offset:5376
    v_cmp_lt_u32 vcc, 9, v17
    v_lshrrev_b32 v21, 23, v146
    s_mov_b64 exec, vcc
    s_cbranch_execz B_BD
    ds_add_rtn_u32 v161, v21, v22 offset:5376
    v_cmp_lt_u32 vcc, 10, v17
    v_lshrrev_b32 v20, 23, v148
    s_mov_b64 exec, vcc
    s_cbranch_execz B_BD
    ds_add_rtn_u32 v162, v20, v22 offset:5376
    v_cmp_lt_u32 vcc, 11, v17
    v_lshrrev_b32 v21, 23, v150
    s_mov_b64 exec, vcc
    s_cbranch_execz B_BD
    ds_add_rtn_u32 v163, v21, v22 offset:5376
B_BD:
    s_mov_b64 exec, -1
K_COUNTED:
    s_waitcnt lgkmcnt(0)
    s_barrier
    v_mbcnt_lo_u32_b32 v23, -1, 0
    v_mbcnt_hi_u32_b32 v23, -1, v23
    v_lshlrev_b32 v20, 3, v23
    ds_read_b64 v[24:25], v20 offset:5376
    v_mov_b32 v26, 5888
    ds_read_b32 v27, v26 offset:16
    ds_read_b32 v26, v26
    v_lshrrev_b32 v23, 4, v23
    v_lshlrev_b32 v23, 12, v23
    v_add_u32 v23, 35648, v23
    s_waitcnt lgkmcnt(0)
    v_readfirstlane_b32 s64, v27
    v_add_u32 v21, v24, v25
    v_mov_b32 v22, v21
    s_cmp_lg_u32 s64, 0
    s_cbranch_scc1 K_HELP1
    v_add_u32_dpp v22, v22, v22 row_shr:1 row_mask:0xf bank_mask:0xf bound_ctrl:1
    s_nop 1
    v_add_u32_dpp v22, v22, v22 row_shr:2 row_mask:0xf bank_mask:0xf bound_ctrl:1
    s_nop 1
    v_add_u32_dpp v22, v22, v22 row_shr:4 row_mask:0xf bank_mask:0xf bound_ctrl:1
    s_nop 1
    v_add_u32_dpp v22, v22, v22 row_shr:8 row_mask:0xf bank_mask:0xf bound_ctrl:1
    s_nop 0
    v_readlane_b32 s70, v22, 15
    v_readlane_b32 s71, v22, 31
    v_readlane_b32 s72, v22, 47
    v_readlane_b32 s73, v22, 63
    v_readfirstlane_b32 s59, v26
    v_sub_u32 v22, v22, v21
    v_add_u32 v28, v22, v23
    v_add_u32 v29, v28, v24
    ds_write_b64 v20, v[28:29] offset:5952
    s_max_u32 s64, s70, s71
    s_max_u32 s65, s72, s73
    s_max_u32 s64, s64, s65
    s_cmp_gt_u32 s64, 4096
    s_cbranch_scc1 K_OVF
    v_cmp_lt_u32 vcc, 0, v17
    v_lshrrev_b32 v32, 23, v128
    v_lshrrev_b32 v33, 23, v130
    v_lshrrev_b32 v34, 23, v132
    v_lshrrev_b32 v35, 23, v134
    s_mov_b64 exec, vcc
    s_cbranch_execz B_CR
    ds_read_b32 v32, v32 offset:5952
    ds_read_b32 v33, v33 offset:5952
    ds_read_b32 v34, v34 offset:5952
    ds_read_b32 v35, v35 offset:5952
    v_cmp_lt_u32 vcc, 4, v17
    v_lshrrev_b32 v36, 23, v136
    v_lshrrev_b32 v37, 23, v138
    v_lshrrev_b32 v38, 23, v140
    v_lshrrev_b32 v39, 23, v142
    s_mov_b64 exec, vcc
    s_cbranch_execz B_CR
    ds_read_b32 v36, v36 offset:5952
    ds_read_b32 v37, v37 offset:5952
    ds_read_b32 v38, v38 offset:5952
    ds_read_b32 v39, v39 offset:5952
    v_cmp_lt_u32 vcc, 8, v17
    v_lshrrev_b32 v40, 23, v144
    v_lshrrev_b32 v41, 23, v146
    v_lshrrev_b32 v42, 23, v148
    v_lshrrev_b32 v43, 23, v150
    s_mov_b64 exec, vcc
    s_cbranch_execz B_CR
    ds_read_b32 v40, v40 offset:5952
    ds_read_b32 v41, v41 offset:5952
    ds_read_b32 v42, v42 offset:5952
    ds_read_b32 v43, v43 offset:5952
B_CR:
    s_mov_b64 exec, -1
    s_lshr_b32 s70, s70, 3
    s_lshr_b32 s71, s71, 3
    s_lshr_b32 s72, s72, 3
    s_lshr_b32 s73, s73, 3
    s_cmp_lg_u32 s68, 0
    s_cbranch_scc1 B_KEEP
    s_lshl_b32 s20, s70, 2
    s_or_b32 s20, s20, 0
    s_lshl_b32 s21, s71, 2
    s_or_b32 s21, s21, 1
    s_lshl_b32 s22, s72, 2
    s_or_b32 s22, s22, 2
    s_lshl_b32 s23, s73, 2
    s_or_b32 s23, s23, 3
    s_max_u32 s64, s20, s21
    s_min_u32 s21, s20, s21
    s_mov_b32 s20, s64
    s_max_u32 s64, s22, s23
    s_min_u32 s23, s22, s23
    s_mov_b32 s22, s64
    s_max_u32 s64, s20, s22
    s_min_u32 s22, s20, s22
    s_mov_b32 s20, s64
    s_max_u32 s64, s21, s23
    s_min_u32 s23, s21, s23
    s_mov_b32 s21, s64
    s_max_u32 s64, s21, s22
    s_min_u32 s22, s21, s22
    s_mov_b32 s21, s64
    s_cmp_eq_u32 s76, 1
    s_cselect_b32 s64, s21, s20
    s_cmp_eq_u32 s76, 2
    s_cselect_b32 s64, s23, s64
    s_cmp_eq_u32 s76, 3
    s_cselect_b32 s64, s22, s64
    s_and_b32 s53, s64, 3
    s_cmp_eq_u32 s76, 1
    s_cselect_b32 s64, s22, s23
    s_cmp_eq_u32 s76, 2
    s_cselect_b32 s64, s20, s64
    s_cmp_eq_u32 s76, 3
    s_cselect_b32 s64, s21, s64
    s_lshr_b32 s78, s64, 2
    s_mul_i32 s78, s78, s69
B_KEEP:
    s_cmp_eq_u32 s53, 1
    s_cselect_b32 s57, s71, s70
    s_cmp_eq_u32 s53, 2
    s_cselect_b32 s57, s72, s57
    s_cmp_eq_u32 s53, 3
    s_cselect_b32 s57, s73, s57
    s_add_u32 s56, s57, 31
    s_lshr_b32 s56, s56, 5
    s_waitcnt lgkmcnt(0)
    v_cmp_lt_u32 vcc, 0, v17
    v_add_u32 v32, v32, v152
    s_mov_b64 exec, vcc
    s_cbranch_execz B_CD
    ds_write_b64 v32, v[128:129]
    v_cmp_lt_u32 vcc, 1, v17
    v_add_u32 v33, v33, v153
    s_mov_b64 exec, vcc
    s_cbranch_execz B_CD
    ds_write_b64 v33, v[130:131]
    v_cmp_lt_u32 vcc, 2, v17
    v_add_u32 v34, v34, v154
    s_mov_b64 exec, vcc
    s_cbranch_execz B_CD
    ds_write_b64 v34, v[132:133]
    v_cmp_lt_u32 vcc, 3, v17
    v_add_u32 v35, v35, v155
    s_mov_b64 exec, vcc
    s_cbranch_execz B_CD
    ds_write_b64 v35, v[134:135]
    v_cmp_lt_u32 vcc, 4, v17
    v_add_u32 v36, v36, v156
    s_mov_b64 exec, vcc
    s_cbranch_execz B_CD
    ds_write_b64 v36, v[136:137]
    v_cmp_lt_u32 vcc, 5, v17
    v_add_u32 v37, v37, v157
    s_mov_b64 exec, vcc
    s_cbranch_execz B_CD
    ds_write_b64 v37, v[138:139]
    v_cmp_lt_u32 vcc, 6, v17
    v_add_u32 v38, v38, v158
    s_mov_b64 exec, vcc
    s_cbranch_execz B_CD
    ds_write_b64 v38, v[140:141]
    v_cmp_lt_u32 vcc, 7, v17
    v_add_u32 v39, v39, v159
    s_mov_b64 exec, vcc
    s_cbranch_execz B_CD
    ds_write_b64 v39, v[142:143]
    v_cmp_lt_u32 vcc, 8, v17
    v_add_u32 v40, v40, v160
    s_mov_b64 exec, vcc
    s_cbranch_execz B_CD
    ds_write_b64 v40, v[144:145]
    v_cmp_lt_u32 vcc, 9, v17
    v_add_u32 v41, v41, v161
    s_mov_b64 exec, vcc
    s_cbranch_execz B_CD
    ds_write_b64 v41, v[146:147]
    v_cmp_lt_u32 vcc, 10, v17
    v_add_u32 v42, v42, v162
    s_mov_b64 exec, vcc
    s_cbranch_execz B_CD
    ds_write_b64 v42, v[148:149]
    v_cmp_lt_u32 vcc, 11, v17
    v_add_u32 v43, v43, v163
    s_mov_b64 exec, vcc
    s_cbranch_execz B_CD
    ds_write_b64 v43, v[150:151]
B_CD:
    s_mov_b64 exec, -1
    v_add_u32 v0, v0, v17
    v_lshlrev_b32 v20, 16, v17
    v_sub_u32 v0, v0, v20
    s_waitcnt lgkmcnt(0)
    s_barrier
    s_cmp_lg_u32 s68, 0
    s_cbranch_scc1 B_NOST
    s_mov_b32 s20, s12
    s_and_b32 s21, s13, 0xffff
    s_mov_b32 s22, 32768
    s_mov_b32 s23, 0x20000
    s_lshl_b32 s64, s52, 12
    s_mov_b32 s66, 0
    s_add_u32 m0, s64, 86016
    s_nop 0
    buffer_load_dwordx4 v14, s[20:23], s66 offen offset:0 lds
    buffer_load_dwordx4 v14, s[20:23], s66 offen offset:1024 lds
    buffer_load_dwordx4 v14, s[20:23], s66 offen offset:2048 lds
    buffer_load_dwordx4 v14, s[20:23], s66 offen offset:3072 lds
    s_mov_b32 s20, s16
    s_and_b32 s21, s17, 0xffff
    s_mov_b32 s22, 69632
    s_mov_b32 s23, 0x20000
    s_lshl_b32 s64, s52, 12
    s_mov_b32 s66, 0
    s_add_u32 m0, s64, 53248
    s_nop 0
    buffer_load_dwordx4 v14, s[20:23], s66 offen offset:0 lds
    buffer_load_dwordx4 v14, s[20:23], s66 offen offset:1024 lds
    buffer_load_dwordx4 v14, s[20:23], s66 offen offset:2048 lds
    buffer_load_dwordx4 v14, s[20:23], s66 offen offset:3072 lds
B_NOST:
    v_mbcnt_lo_u32_b32 v20, -1, 0
    v_mbcnt_hi_u32_b32 v20, -1, v20
    v_and_b32 v21, 31, v20
    s_lshl_b32 s64, s53, 12
    s_add_u32 s64, s64, 35652
    v_lshl_add_u32 v22, v21, 3, s64
    s_lshl_b32 s64, s54, 8
    v_add_u32 v23, s64, v22
    ds_read_b32 v32, v23 offset:0
    ds_read_b32 v33, v23 offset:512
    ds_read_b32 v34, v23 offset:1024
    ds_read_b32 v35, v23 offset:1536
    ds_read_b32 v36, v23 offset:2048
    ds_read_b32 v168, v22 offset:2560
    ds_read_b32 v172, v22 offset:2816
    ds_read_b32 v176, v22 offset:3072
    ds_read_b32 v180, v22 offset:3328
    ds_read_b32 v184, v22 offset:3584
    ds_read_b32 v188, v22 offset:3840
    v_lshrrev_b32 v20, 5, v20
    v_lshlrev_b32 v20, 4, v20
    v_sub_u32 v21, s57, v21
    s_lshl_b32 s64, s54, 5
    v_subrev_u32 v23, s64, v21
    v_mov_b32 v22, 2147483392
    s_waitcnt lgkmcnt(10)
    v_cmp_lt_i32 vcc, 0, v23
    v_add_u32 v32, v32, v20
    s_nop 0
    v_cndmask_b32 v32, v22, v32, vcc
    s_barrier
    buffer_load_dwordx4 v[128:131], v32, s[28:31], 0 offen
    s_waitcnt lgkmcnt(9)
    v_cmp_lt_i32 vcc, 64, v23
    v_add_u32 v33, v33, v20
    s_nop 0
    v_cndmask_b32 v33, v22, v33, vcc
    buffer_load_dwordx4 v[132:135], v33, s[28:31], 0 offen
    s_waitcnt lgkmcnt(8)
    v_cmp_lt_i32 vcc, 128, v23
    v_add_u32 v34, v34, v20
    s_nop 0
    v_cndmask_b32 v34, v22, v34, vcc
    s_waitcnt lgkmcnt(7)
    v_cmp_lt_i32 vcc, 192, v23
    v_add_u32 v35, v35, v20
    s_nop 0
    v_cndmask_b32 v35, v22, v35, vcc
    s_waitcnt lgkmcnt(6)
    v_cmp_lt_i32 vcc, 256, v23
    v_add_u32 v36, v36, v20
    s_nop 0
    v_cndmask_b32 v36, v22, v36, vcc
    s_waitcnt lgkmcnt(5)
    v_cmp_lt_i32 vcc, 320, v21
    v_add_u32 v168, v168, v20
    s_nop 0
    v_cndmask_b32 v168, v22, v168, vcc
    s_waitcnt lgkmcnt(4)
    v_cmp_lt_i32 vcc, 352, v21
    v_add_u32 v172, v172, v20
    s_nop 0
    v_cndmask_b32 v172, v22, v172, vcc
    s_waitcnt lgkmcnt(3)
    v_cmp_lt_i32 vcc, 384, v21
    v_add_u32 v176, v176, v20
    s_nop 0
    v_cndmask_b32 v176, v22, v176, vcc
    s_waitcnt lgkmcnt(2)
    v_cmp_lt_i32 vcc, 416, v21
    v_add_u32 v180, v180, v20
    s_nop 0
    v_cndmask_b32 v180, v22, v180, vcc
    s_waitcnt lgkmcnt(1)
    v_cmp_lt_i32 vcc, 448, v21
    v_add_u32 v184, v184, v20
    s_nop 0
    v_cndmask_b32 v184, v22, v184, vcc
    s_waitcnt lgkmcnt(0)
    v_cmp_lt_i32 vcc, 480, v21
    v_add_u32 v188, v188, v20
    s_nop 0
    v_cndmask_b32 v188, v22, v188, vcc
    s_lshl_b32 s64, s53, 3
    s_lshr_b32 s66, 1227954432, s64
    s_and_b32 s66, s66, 0xff
    s_lshr_b32 s75, 421009433, s64
    s_and_b32 s75, s75, 0xff
    s_mul_i32 s67, s2, 98
    s_add_u32 s67, s67, s66
    s_cmp_lg_u32 s68, 0
    s_cbranch_scc1 K_PLAIN
    v_mov_b32 v24, 0
    v_mov_b32 v28, 0x80808080
    v_mov_b32 v25, 0
    v_mov_b32 v29, 0x80808080
    v_mov_b32 v26, 0
    v_mov_b32 v30, 0x80808080
    v_mov_b32 v27, 0
    v_mov_b32 v31, 0x80808080
    v_lshlrev_b32 v20, 4, v16
    ds_write_b128 v20, v[24:27] offset:19264
    ds_write_b128 v20, v[24:27] offset:27456
    ds_write_b128 v20, v[28:31] offset:11072
    v_cmp_gt_u32 vcc, 288, v16
    s_nop 0
    s_mov_b64 exec, vcc
    s_cbranch_execz K_I0
    ds_write_b128 v20, v[24:27] offset:6464
    v_cmp_gt_u32 vcc, 0, v16
    s_nop 0
    s_mov_b64 exec, vcc
    s_cbranch_execz K_I0
    ds_write_b128 v20, v[24:27] offset:35648
    v_cmp_gt_u32 vcc, 0, v16
    s_nop 0
    s_mov_b64 exec, vcc
    s_cbranch_execz K_I0
    ds_write_b128 v20, v[28:31] offset:19264
K_I0:
    s_mov_b64 exec, -1
    s_waitcnt vmcnt(2)
    v_mov_b32 v20, 5916
    v_mov_b32 v21, 1
    s_mov_b64 exec, 1
    ds_add_rtn_u32 v22, v20, v21
    s_mov_b64 exec, -1
    s_waitcnt lgkmcnt(0)
    v_readfirstlane_b32 s64, v22
    s_nop 0
    s_cmp_lg_u32 s64, 7
    s_cbranch_scc1 K_NOS2
    v_mbcnt_lo_u32_b32 v20, -1, 0
    v_mbcnt_hi_u32_b32 v20, -1, v20
    s_lshl_b32 s64, s2, 2
    s_add_u32 s64, s64, 8192
    v_cmp_gt_u32 vcc, 8, v20
    v_lshl_add_u32 v20, v20, 10, s64
    v_mov_b32 v21, s79
    s_mov_b64 exec, vcc
    buffer_store_dword v21, v20, s[4:7], 0 offen sc1
    s_mov_b64 exec, -1
K_NOS2:
    v_mbcnt_lo_u32_b32 v20, -1, 0
    v_mbcnt_hi_u32_b32 v20, -1, v20
    s_mul_i32 s64, s53, 2048
    s_add_u32 s64, s64, 11072
    v_and_b32 v21, 31, v20
    v_lshl_add_u32 v14, v21, 2, s64
    v_lshrrev_b32 v21, 5, v20
    v_add_u32 v14, v21, v14
    s_mul_i32 s64, s53, 4096
    s_add_u32 s64, s64, 19264
    v_lshl_add_u32 v15, v20, 2, s64
    s_mul_i32 s64, s53, 1152
    s_add_u32 s64, s64, 6464
    v_lshrrev_b32 v21, 3, v20
    v_lshl_add_u32 v7, v21, 3, s64
    v_mbcnt_lo_u32_b32 v20, -1, 0
    v_mbcnt_hi_u32_b32 v20, -1, v20
    v_and_b32 v21, 15, v20
    v_lshrrev_b32 v22, 5, v20
    v_xor_b32 v21, v21, v22
    v_lshlrev_b32 v21, 4, v21
    v_and_b32 v20, 31, v20
    v_lshl_add_u32 v22, v20, 8, v21
    s_lshl_b32 s64, s53, 13
    s_add_u32 s64, s64, 118784
    v_add_u32 v22, s64, v22
    v_xor_b32 v21, 0, v22
    ds_read_b128 v[96:99], v21
    v_xor_b32 v21, 32, v22
    ds_read_b128 v[100:103], v21
    v_xor_b32 v21, 64, v22
    ds_read_b128 v[104:107], v21
    v_xor_b32 v21, 96, v22
    ds_read_b128 v[108:111], v21
    v_xor_b32 v21, 128, v22
    ds_read_b128 v[112:115], v21
    v_xor_b32 v21, 160, v22
    ds_read_b128 v[116:119], v21
    v_xor_b32 v21, 192, v22
    ds_read_b128 v[120:123], v21
    v_xor_b32 v21, 224, v22
    ds_read_b128 v[124:127], v21
    buffer_load_dwordx4 v[136:139], v34, s[28:31], 0 offen
    s_waitcnt lgkmcnt(0)
    s_barrier
    ds_read_b64_tr_b16 v[48:49], v18 offset:0
    ds_read_b64_tr_b16 v[50:51], v18 offset:1024
    ds_read_b64_tr_b16 v[52:53], v18 offset:32768
    ds_read_b64_tr_b16 v[54:55], v18 offset:33792
    ds_read_b64_tr_b16 v[56:57], v18 offset:4096
    ds_read_b64_tr_b16 v[58:59], v18 offset:5120
    ds_read_b64_tr_b16 v[60:61], v18 offset:36864
    ds_read_b64_tr_b16 v[62:63], v18 offset:37888
    s_waitcnt lgkmcnt(4)
    v_mfma_f32_32x32x16_bf16 v[64:79], v[96:99], v[48:51], 0
    v_mfma_f32_32x32x16_bf16 v[192:207], v[52:55], v[96:99], 0
    ds_read_b64_tr_b16 v[48:49], v18 offset:8192
    ds_read_b64_tr_b16 v[50:51], v18 offset:9216
    ds_read_b64_tr_b16 v[52:53], v18 offset:40960
    ds_read_b64_tr_b16 v[54:55], v18 offset:41984
    buffer_load_dwordx4 v[140:143], v35, s[28:31], 0 offen
    s_waitcnt lgkmcnt(4)
    v_mfma_f32_32x32x16_bf16 v[64:79], v[100:103], v[56:59], v[64:79]
    v_mfma_f32_32x32x16_bf16 v[192:207], v[60:63], v[100:103], v[192:207]
    ds_read_b64_tr_b16 v[56:57], v18 offset:12288
    ds_read_b64_tr_b16 v[58:59], v18 offset:13312
    ds_read_b64_tr_b16 v[60:61], v18 offset:45056
    ds_read_b64_tr_b16 v[62:63], v18 offset:46080
    s_waitcnt lgkmcnt(4)
    v_mfma_f32_32x32x16_bf16 v[64:79], v[104:107], v[48:51], v[64:79]
    v_mfma_f32_32x32x16_bf16 v[192:207], v[52:55], v[104:107], v[192:207]
    ds_read_b64_tr_b16 v[48:49], v18 offset:16384
    ds_read_b64_tr_b16 v[50:51], v18 offset:17408
    ds_read_b64_tr_b16 v[52:53], v18 offset:49152
    ds_read_b64_tr_b16 v[54:55], v18 offset:50176
    s_waitcnt lgkmcnt(4)
    v_mfma_f32_32x32x16_bf16 v[64:79], v[108:111], v[56:59], v[64:79]
    v_mfma_f32_32x32x16_bf16 v[192:207], v[60:63], v[108:111], v[192:207]
    ds_read_b64_tr_b16 v[56:57], v18 offset:20480
    ds_read_b64_tr_b16 v[58:59], v18 offset:21504
    ds_read_b64_tr_b16 v[60:61], v18 offset:53248
    ds_read_b64_tr_b16 v[62:63], v18 offset:54272
    s_waitcnt lgkmcnt(4)
    v_mfma_f32_32x32x16_bf16 v[64:79], v[112:115], v[48:51], v[64:79]
    v_mfma_f32_32x32x16_bf16 v[192:207], v[52:55], v[112:115], v[192:207]
    ds_read_b64_tr_b16 v[48:49], v18 offset:24576
    ds_read_b64_tr_b16 v[50:51], v18 offset:25600
    ds_read_b64_tr_b16 v[52:53], v18 offset:57344
    ds_read_b64_tr_b16 v[54:55], v18 offset:58368
    s_waitcnt lgkmcnt(4)
    v_mfma_f32_32x32x16_bf16 v[64:79], v[116:119], v[56:59], v[64:79]
    v_mfma_f32_32x32x16_bf16 v[192:207], v[60:63], v[116:119], v[192:207]
    ds_read_b64_tr_b16 v[56:57], v18 offset:28672
    ds_read_b64_tr_b16 v[58:59], v18 offset:29696
    ds_read_b64_tr_b16 v[60:61], v18 offset:61440
    ds_read_b64_tr_b16 v[62:63], v18 offset:62464
    s_waitcnt lgkmcnt(4)
    v_mfma_f32_32x32x16_bf16 v[64:79], v[120:123], v[48:51], v[64:79]
    v_mfma_f32_32x32x16_bf16 v[192:207], v[52:55], v[120:123], v[192:207]
    s_waitcnt lgkmcnt(0)
    v_mfma_f32_32x32x16_bf16 v[64:79], v[124:127], v[56:59], v[64:79]
    v_mfma_f32_32x32x16_bf16 v[192:207], v[60:63], v[124:127], v[192:207]
    ds_read_b64_tr_b16 v[48:49], v19 offset:0
    ds_read_b64_tr_b16 v[50:51], v19 offset:1024
    ds_read_b64_tr_b16 v[52:53], v19 offset:32768
    ds_read_b64_tr_b16 v[54:55], v19 offset:33792
    ds_read_b64_tr_b16 v[56:57], v19 offset:4096
    ds_read_b64_tr_b16 v[58:59], v19 offset:5120
    ds_read_b64_tr_b16 v[60:61], v19 offset:36864
    ds_read_b64_tr_b16 v[62:63], v19 offset:37888
    s_waitcnt lgkmcnt(4)
    v_mfma_f32_32x32x16_bf16 v[80:95], v[96:99], v[48:51], 0
    v_mfma_f32_32x32x16_bf16 v[208:223], v[52:55], v[96:99], 0
    ds_read_b64_tr_b16 v[48:49], v19 offset:8192
    ds_read_b64_tr_b16 v[50:51], v19 offset:9216
    ds_read_b64_tr_b16 v[52:53], v19 offset:40960
    ds_read_b64_tr_b16 v[54:55], v19 offset:41984
    s_waitcnt lgkmcnt(4)
    v_mfma_f32_32x32x16_bf16 v[80:95], v[100:103], v[56:59], v[80:95]
    v_mfma_f32_32x32x16_bf16 v[208:223], v[60:63], v[100:103], v[208:223]
    ds_read_b64_tr_b16 v[56:57], v19 offset:12288
    ds_read_b64_tr_b16 v[58:59], v19 offset:13312
    ds_read_b64_tr_b16 v[60:61], v19 offset:45056
    ds_read_b64_tr_b16 v[62:63], v19 offset:46080
    s_waitcnt lgkmcnt(4)
    v_mfma_f32_32x32x16_bf16 v[80:95], v[104:107], v[48:51], v[80:95]
    v_mfma_f32_32x32x16_bf16 v[208:223], v[52:55], v[104:107], v[208:223]
    ds_read_b64_tr_b16 v[48:49], v19 offset:16384
    ds_read_b64_tr_b16 v[50:51], v19 offset:17408
    ds_read_b64_tr_b16 v[52:53], v19 offset:49152
    ds_read_b64_tr_b16 v[54:55], v19 offset:50176
    s_waitcnt lgkmcnt(4)
    v_mfma_f32_32x32x16_bf16 v[80:95], v[108:111], v[56:59], v[80:95]
    v_mfma_f32_32x32x16_bf16 v[208:223], v[60:63], v[108:111], v[208:223]
    ds_read_b64_tr_b16 v[56:57], v19 offset:20480
    ds_read_b64_tr_b16 v[58:59], v19 offset:21504
    ds_read_b64_tr_b16 v[60:61], v19 offset:53248
    ds_read_b64_tr_b16 v[62:63], v19 offset:54272
    s_waitcnt lgkmcnt(4)
    v_mfma_f32_32x32x16_bf16 v[80:95], v[112:115], v[48:51], v[80:95]
    v_mfma_f32_32x32x16_bf16 v[208:223], v[52:55], v[112:115], v[208:223]
    ds_read_b64_tr_b16 v[48:49], v19 offset:24576
    ds_read_b64_tr_b16 v[50:51], v19 offset:25600
    ds_read_b64_tr_b16 v[52:53], v19 offset:57344
    ds_read_b64_tr_b16 v[54:55], v19 offset:58368
    s_waitcnt lgkmcnt(4)
    v_mfma_f32_32x32x16_bf16 v[80:95], v[116:119], v[56:59], v[80:95]
    v_mfma_f32_32x32x16_bf16 v[208:223], v[60:63], v[116:119], v[208:223]
    ds_read_b64_tr_b16 v[56:57], v19 offset:28672
    ds_read_b64_tr_b16 v[58:59], v19 offset:29696
    ds_read_b64_tr_b16 v[60:61], v19 offset:61440
    ds_read_b64_tr_b16 v[62:63], v19 offset:62464
    s_waitcnt lgkmcnt(4)
    v_mfma_f32_32x32x16_bf16 v[80:95], v[120:123], v[48:51], v[80:95]
    v_mfma_f32_32x32x16_bf16 v[208:223], v[52:55], v[120:123], v[208:223]
    s_waitcnt lgkmcnt(0)
    v_mfma_f32_32x32x16_bf16 v[80:95], v[124:127], v[56:59], v[80:95]
    v_mfma_f32_32x32x16_bf16 v[208:223], v[60:63], v[124:127], v[208:223]
    v_mul_f32 v64, s63, v64
    v_mul_f32 v65, s63, v65
    v_mul_f32 v66, s63, v66
    v_mul_f32 v67, s63, v67
    v_mul_f32 v68, s63, v68
    v_mul_f32 v69, s63, v69
    v_mul_f32 v70, s63, v70
    v_mul_f32 v71, s63, v71
    v_mul_f32 v72, s63, v72
    v_mul_f32 v73, s63, v73
    v_mul_f32 v74, s63, v74
    v_mul_f32 v75, s63, v75
    v_mul_f32 v76, s63, v76
    v_mul_f32 v77, s63, v77
    v_mul_f32 v78, s63, v78
    v_mul_f32 v79, s63, v79
    v_cvt_pk_f16_f32 v224, v64, v65
    v_cvt_pk_f16_f32 v225, v66, v67
    v_cvt_pk_f16_f32 v226, v68, v69
    v_cvt_pk_f16_f32 v227, v70, v71
    v_cvt_pk_f16_f32 v228, v72, v73
    v_cvt_pk_f16_f32 v229, v74, v75
    v_cvt_pk_f16_f32 v230, v76, v77
    v_cvt_pk_f16_f32 v231, v78, v79
    v_mul_f32 v80, s63, v80
    v_mul_f32 v81, s63, v81
    v_mul_f32 v82, s63, v82
    v_mul_f32 v83, s63, v83
    v_mul_f32 v84, s63, v84
    v_mul_f32 v85, s63, v85
    v_mul_f32 v86, s63, v86
    v_mul_f32 v87, s63, v87
    v_mul_f32 v88, s63, v88
    v_mul_f32 v89, s63, v89
    v_mul_f32 v90, s63, v90
    v_mul_f32 v91, s63, v91
    v_mul_f32 v92, s63, v92
    v_mul_f32 v93, s63, v93
    v_mul_f32 v94, s63, v94
    v_mul_f32 v95, s63, v95
    v_cvt_pk_f16_f32 v232, v80, v81
    v_cvt_pk_f16_f32 v233, v82, v83
    v_cvt_pk_f16_f32 v234, v84, v85
    v_cvt_pk_f16_f32 v235, v86, v87
    v_cvt_pk_f16_f32 v236, v88, v89
    v_cvt_pk_f16_f32 v237, v90, v91
    v_cvt_pk_f16_f32 v238, v92, v93
    v_cvt_pk_f16_f32 v239, v94, v95
    s_cmp_lg_u32 s52, 0
    s_cbranch_scc1 P_NOLD
    v_mbcnt_lo_u32_b32 v44, -1, 0
    v_mbcnt_hi_u32_b32 v44, -1, v44
    s_and_b32 s64, s3, 7
    s_lshl_b32 s64, s64, 10
    s_add_u32 s64, s64, 8192
    v_lshl_add_u32 v44, v44, 4, s64
    buffer_load_dwordx4 v[40:43], v44, s[4:7], 0 offen sc1
P_NOLD:
    buffer_load_dwordx4 v[144:147], v36, s[28:31], 0 offen
    v_lshlrev_b32 v21, 3, v16
    ds_read_b32 v24, v21 offset:35648
    ds_read_b32 v25, v21 offset:39744
    ds_read_b32 v26, v21 offset:43840
    ds_read_b32 v27, v21 offset:47936
    v_and_b32 v21, 7, v16
    v_lshlrev_b32 v21, 3, v21
    v_bfe_u32 v22, v16, 3, 2
    v_lshl_add_u32 v21, v22, 1, v21
    v_lshrrev_b32 v22, 5, v16
    v_lshl_add_u32 v21, v22, 6, v21
    v_lshlrev_b32 v22, 8, v22
    v_bfe_u32 v23, v16, 2, 1
    v_lshl_add_u32 v22, v23, 7, v22
    v_bfe_u32 v23, v16, 3, 1
    v_and_b32 v12, 3, v16
    v_lshl_add_u32 v12, v23, 2, v12
    v_or_b32 v12, 0x0c0c0c00, v12
    v_mov_b32 v13, 134480385
    s_mov_b32 s64, 2840995091
    v_perm_b32 v12, s64, v13, v12
    v_and_b32 v23, 16, v16
    v_add_u32 v23, 4, v23
    v_lshlrev_b32 v12, v23, v12
    v_lshlrev_b32 v23, 2, v16
    s_waitcnt lgkmcnt(0)
    v_cmp_gt_u32 vcc, s70, v16
    s_nop 0
    s_mov_b64 exec, vcc
    s_cbranch_execz K_D0
    v_and_b32 v29, 0x7fff, v24
    ds_write_b16 v21, v29 offset:6464
    v_bfe_u32 v28, v24, 15, 5
    v_lshl_add_u32 v29, v28, 2, v22
    ds_add_u32 v29, v12 offset:19264
    v_and_b32 v29, 3, v28
    v_mul_u32_u24 v29, 0x5555, v29
    ds_write_b16 v23, v29 offset:11074
    v_lshrrev_b32 v29, 4, v28
    v_add_u32 v29, v29, v23
    v_and_b32 v24, 8, v28
    v_lshlrev_b32 v24, 2, v24
    v_and_b32 v28, 4, v28
    v_lshl_or_b32 v24, v28, 4, v24
    ds_write_b8 v29, v24 offset:11072
K_D0:
    s_mov_b64 exec, -1
    v_cmp_gt_u32 vcc, s71, v16
    s_nop 0
    s_mov_b64 exec, vcc
    s_cbranch_execz K_D1
    v_and_b32 v29, 0x7fff, v25
    ds_write_b16 v21, v29 offset:7616
    v_bfe_u32 v28, v25, 15, 5
    v_lshl_add_u32 v29, v28, 2, v22
    ds_add_u32 v29, v12 offset:23360
    v_and_b32 v29, 3, v28
    v_mul_u32_u24 v29, 0x5555, v29
    ds_write_b16 v23, v29 offset:13122
    v_lshrrev_b32 v29, 4, v28
    v_add_u32 v29, v29, v23
    v_and_b32 v25, 8, v28
    v_lshlrev_b32 v25, 2, v25
    v_and_b32 v28, 4, v28
    v_lshl_or_b32 v25, v28, 4, v25
    ds_write_b8 v29, v25 offset:13120
K_D1:
    s_mov_b64 exec, -1
    v_cmp_gt_u32 vcc, s72, v16
    s_nop 0
    s_mov_b64 exec, vcc
    s_cbranch_execz K_D2
    v_and_b32 v29, 0x7fff, v26
    ds_write_b16 v21, v29 offset:8768
    v_bfe_u32 v28, v26, 15, 5
    v_lshl_add_u32 v29, v28, 2, v22
    ds_add_u32 v29, v12 offset:27456
    v_and_b32 v29, 3, v28
    v_mul_u32_u24 v29, 0x5555, v29
    ds_write_b16 v23, v29 offset:15170
    v_lshrrev_b32 v29, 4, v28
    v_add_u32 v29, v29, v23
    v_and_b32 v26, 8, v28
    v_lshlrev_b32 v26, 2, v26
    v_and_b32 v28, 4, v28
    v_lshl_or_b32 v26, v28, 4, v26
    ds_write_b8 v29, v26 offset:15168
K_D2:
    s_mov_b64 exec, -1
    v_cmp_gt_u32 vcc, s73, v16
    s_nop 0
    s_mov_b64 exec, vcc
    s_cbranch_execz K_D3
    v_and_b32 v29, 0x7fff, v27
    ds_write_b16 v21, v29 offset:9920
    v_bfe_u32 v28, v27, 15, 5
    v_lshl_add_u32 v29, v28, 2, v22
    ds_add_u32 v29, v12 offset:31552
    v_and_b32 v29, 3, v28
    v_mul_u32_u24 v29, 0x5555, v29
    ds_write_b16 v23, v29 offset:17218
    v_lshrrev_b32 v29, 4, v28
    v_add_u32 v29, v29, v23
    v_and_b32 v27, 8, v28
    v_lshlrev_b32 v27, 2, v27
    v_and_b32 v28, 4, v28
    v_lshl_or_b32 v27, v28, 4, v27
    ds_write_b8 v29, v27 offset:17216
K_D3:
    s_mov_b64 exec, -1
    s_waitcnt lgkmcnt(0)
    s_cmp_lg_u32 s52, 0
    s_cbranch_scc1 P_D
    s_mov_b32 s65, 0
    s_waitcnt vmcnt(1)
P_L:
    v_xor_b32 v40, s79, v40
    v_xor_b32 v41, s79, v41
    v_xor_b32 v42, s79, v42
    v_xor_b32 v43, s79, v43
    v_or_b32 v40, v40, v41
    v_or3_b32 v40, v40, v42, v43
    v_cmp_ne_u32 vcc, 0, v40
    s_cbranch_vccz P_D
    s_sleep 2
    buffer_load_dwordx4 v[40:43], v44, s[4:7], 0 offen sc1
    s_add_u32 s65, s65, 1
    s_cmp_lt_u32 s65, 4000
    s_waitcnt vmcnt(0)
    s_cbranch_scc1 P_L
    v_mov_b32 v20, 5908
    v_mov_b32 v21, 1
    ds_write_b32 v20, v21
P_D:
    s_waitcnt lgkmcnt(0)
    s_barrier
    v_mov_b32 v23, 5908
    ds_read_b32 v23, v23
    ds_read_b64 v[12:13], v7 offset:0
    s_waitcnt lgkmcnt(1)
    v_readfirstlane_b32 s64, v23
    s_nop 0
    s_cmp_lg_u32 s64, 0
    s_cbranch_scc1 K_HELP2
K_GO:
    s_waitcnt lgkmcnt(0)
    v_mad_u32_u16 v8, v12, s60, v5
    v_mad_u32_u16 v9, v12, s60, v6 op_sel:[1,0,0,0]
    v_mad_u32_u16 v10, v13, s60, v5
    v_mad_u32_u16 v11, v13, s60, v6 op_sel:[1,0,0,0]
    ds_read_b64 v[12:13], v7 offset:64
    s_add_u32 m0, s55, 0
    s_nop 0
    buffer_load_dwordx4 v8, s[36:39], s61 offen lds
    s_add_u32 m0, s55, 1024
    s_nop 0
    buffer_load_dwordx4 v9, s[36:39], s61 offen lds
    s_add_u32 m0, s55, 2048
    s_nop 0
    buffer_load_dwordx4 v10, s[36:39], s61 offen lds
    s_add_u32 m0, s55, 3072
    s_nop 0
    buffer_load_dwordx4 v11, s[36:39], s61 offen lds
    s_add_u32 m0, s55, 4096
    s_nop 0
    buffer_load_dwordx4 v8, s[36:39], s62 offen lds
    s_add_u32 m0, s55, 5120
    s_nop 0
    buffer_load_dwordx4 v9, s[36:39], s62 offen lds
    s_add_u32 m0, s55, 6144
    s_nop 0
    buffer_load_dwordx4 v10, s[36:39], s62 offen lds
    s_add_u32 m0, s55, 7168
    s_nop 0
    buffer_load_dwordx4 v11, s[36:39], s62 offen lds
    v_and_b32 v53, -4, v14
    v_add_u32 v53, 2, v53
    ds_read_u8 v16, v14 offset:0
    ds_read_u16 v18, v15 offset:0
    ds_read_u16 v19, v15 offset:2
    s_waitcnt lgkmcnt(2)
    ds_read_b128 v[48:51], v16 offset:5232
    ds_read_u16 v52, v53 offset:0
    s_waitcnt vmcnt(8)
    s_xor_b32 s66, s52, 1
    v_mbcnt_lo_u32_b32 v20, -1, 0
    v_mbcnt_hi_u32_b32 v20, -1, v20
    s_mul_i32 s64, s66, 12288
    s_add_u32 s64, s64, 61440
    s_lshl_b32 s65, s66, 10
    s_add_u32 s65, s65, 155648
    v_lshl_add_u32 v21, v20, 4, s65
    v_lshl_add_u32 v20, v20, 4, s64
    ds_write_b128 v20, v[128:131] offset:0
    ds_write_b128 v20, v[132:135] offset:1024
    ds_write_b128 v20, v[136:139] offset:2048
    ds_write_b128 v20, v[140:143] offset:3072
    ds_write_b128 v21, v[144:147] offset:0
    s_waitcnt lgkmcnt(0)
    s_barrier
    v_mbcnt_lo_u32_b32 v20, -1, 0
    v_mbcnt_hi_u32_b32 v20, -1, v20
    s_mul_i32 s64, s52, 12288
    s_add_u32 s64, s64, 61440
    s_lshl_b32 s65, s52, 10
    s_add_u32 s65, s65, 155648
    v_lshl_add_u32 v21, v20, 4, s65
    v_lshl_add_u32 v20, v20, 4, s64
    ds_read_b128 v[148:151], v20 offset:0
    ds_read_b128 v[152:155], v20 offset:1024
    ds_read_b128 v[156:159], v20 offset:2048
    ds_read_b128 v[160:163], v20 offset:3072
    ds_read_b128 v[164:167], v21 offset:0
    s_waitcnt lgkmcnt(0)
    s_cmp_eq_u32 s54, 0
    s_cbranch_scc1 K_NOSWAP
    v_swap_b32 v128, v148
    v_swap_b32 v129, v149
    v_swap_b32 v130, v150
    v_swap_b32 v131, v151
    v_swap_b32 v132, v152
    v_swap_b32 v133, v153
    v_swap_b32 v134, v154
    v_swap_b32 v135, v155
    v_swap_b32 v136, v156
    v_swap_b32 v137, v157
    v_swap_b32 v138, v158
    v_swap_b32 v139, v159
    v_swap_b32 v140, v160
    v_swap_b32 v141, v161
    v_swap_b32 v142, v162
    v_swap_b32 v143, v163
    v_swap_b32 v144, v164
    v_swap_b32 v145, v165
    v_swap_b32 v146, v166
    v_swap_b32 v147, v167
K_NOSWAP:
    s_cmp_eq_u32 s56, 0
    s_cbranch_scc1 K_RDONE
    s_and_b32 s64, s52, 3
    s_lshl_b32 s64, s64, 2
    s_add_u32 s64, s64, 5920
    v_mov_b32 v20, s64
    v_mbcnt_lo_u32_b32 v22, -1, 0
    v_mbcnt_hi_u32_b32 v22, -1, v22
    v_cmp_eq_u32 vcc, 0, v22
    v_mov_b32 v21, s78
    v_lshlrev_b32 v22, 2, v22
    v_cndmask_b32 v21, 0, v21, vcc
    v_cndmask_b32 v20, v22, v20, vcc
    s_waitcnt vmcnt(4)
    ds_read_b128 v[32:35], v1 offset:0
    ds_read_b128 v[36:39], v2 offset:0
    ds_read_b128 v[40:43], v3 offset:0
    ds_read_b128 v[44:47], v4 offset:0
    s_waitcnt lgkmcnt(0)
    v_mad_u32_u16 v8, v12, s60, v5
    v_mad_u32_u16 v9, v12, s60, v6 op_sel:[1,0,0,0]
    v_mad_u32_u16 v10, v13, s60, v5
    v_mad_u32_u16 v11, v13, s60, v6 op_sel:[1,0,0,0]
    s_add_u32 m0, s55, 8192
    s_nop 0
    buffer_load_dwordx4 v8, s[36:39], s61 offen lds
    s_add_u32 m0, s55, 9216
    s_nop 0
    buffer_load_dwordx4 v9, s[36:39], s61 offen lds
    s_add_u32 m0, s55, 10240
    s_nop 0
    buffer_load_dwordx4 v10, s[36:39], s61 offen lds
    s_add_u32 m0, s55, 11264
    s_nop 0
    buffer_load_dwordx4 v11, s[36:39], s61 offen lds
    v_mfma_f32_32x32x16_f16 v[64:79], v[32:35], v[248:251], 0
    v_mfma_f32_32x32x16_bf16 v[80:95], v[40:43], v[248:251], 0
    v_mfma_f32_32x32x16_f16 v[64:79], v[36:39], v[252:255], v[64:79]
    v_mfma_f32_32x32x16_bf16 v[80:95], v[44:47], v[252:255], v[80:95]
    s_waitcnt vmcnt(4)
    ds_read_b128 v[32:35], v1 offset:4096
    ds_read_b128 v[36:39], v2 offset:4096
    ds_read_b128 v[40:43], v3 offset:4096
    ds_read_b128 v[44:47], v4 offset:4096
    v_mfma_f32_32x32x16_bf16 v[64:79], v[128:131], v[240:243], v[64:79]
    v_smfmac_f32_32x32x32_f16 v[64:79], v[48:51], v[224:231], v52
    s_waitcnt lgkmcnt(0)
    s_add_u32 m0, s55, 0
    s_nop 0
    buffer_load_dwordx4 v8, s[36:39], s62 offen lds
    s_add_u32 m0, s55, 1024
    s_nop 0
    buffer_load_dwordx4 v9, s[36:39], s62 offen lds
    s_add_u32 m0, s55, 2048
    s_nop 0
    buffer_load_dwordx4 v10, s[36:39], s62 offen lds
    s_add_u32 m0, s55, 3072
    s_nop 0
    buffer_load_dwordx4 v11, s[36:39], s62 offen lds
    s_cmp_eq_u32 s56, 1
    s_cbranch_scc1 K_ST0
    s_waitcnt lgkmcnt(0)
    v_mfma_f32_32x32x16_f16 v[96:111], v[32:35], v[248:251], 0
    ds_read_b64 v[12:13], v7 offset:128
    v_exp_f32 v64, v64
    v_mfma_f32_32x32x16_bf16 v[112:127], v[40:43], v[248:251], 0
    ds_read_u8 v16, v14 offset:128
    v_exp_f32 v65, v65
    v_fma_f32 v64, v64, v80, v80
    v_exp_f32 v66, v66
    v_fma_f32 v65, v65, v81, v81
    v_rcp_f32 v64, v64
    v_mfma_f32_32x32x16_f16 v[96:111], v[36:39], v[252:255], v[96:111]
    v_exp_f32 v67, v67
    v_fma_f32 v66, v66, v82, v82
    v_rcp_f32 v65, v65
    v_mfma_f32_32x32x16_bf16 v[112:127], v[44:47], v[252:255], v[112:127]
    v_exp_f32 v68, v68
    v_fma_f32 v67, v67, v83, v83
    v_rcp_f32 v66, v66
    v_cvt_pk_bf16_f32 v24, v64, v65
    s_waitcnt vmcnt(4)
    ds_read_b128 v[32:35], v1 offset:8192
    v_exp_f32 v69, v69
    v_fma_f32 v68, v68, v84, v84
    v_rcp_f32 v67, v67
    v_mfma_f32_32x32x16_bf16 v[96:111], v[128:131], v[244:247], v[96:111]
    ds_read_b128 v[36:39], v2 offset:8192
    v_exp_f32 v70, v70
    v_fma_f32 v69, v69, v85, v85
    v_rcp_f32 v68, v68
    v_cvt_pk_bf16_f32 v25, v66, v67
    v_smfmac_f32_32x32x32_f16 v[96:111], v[48:51], v[232:239], v52
    ds_read_b128 v[40:43], v3 offset:8192
    v_exp_f32 v71, v71
    v_fma_f32 v70, v70, v86, v86
    v_rcp_f32 v69, v69
    ds_read_b128 v[44:47], v4 offset:8192
    v_exp_f32 v72, v72
    v_fma_f32 v71, v71, v87, v87
    v_rcp_f32 v70, v70
    v_cvt_pk_bf16_f32 v26, v68, v69
    v_exp_f32 v73, v73
    v_fma_f32 v72, v72, v88, v88
    v_rcp_f32 v71, v71
    v_exp_f32 v74, v74
    v_fma_f32 v73, v73, v89, v89
    v_rcp_f32 v72, v72
    v_cvt_pk_bf16_f32 v27, v70, v71
    s_waitcnt lgkmcnt(5)
    v_mad_u32_u16 v8, v12, s60, v5
    v_mad_u32_u16 v9, v12, s60, v6 op_sel:[1,0,0,0]
    v_mad_u32_u16 v10, v13, s60, v5
    v_mad_u32_u16 v11, v13, s60, v6 op_sel:[1,0,0,0]
    s_add_u32 m0, s55, 4096
    v_exp_f32 v75, v75
    v_fma_f32 v74, v74, v90, v90
    v_rcp_f32 v73, v73
    buffer_load_dwordx4 v8, s[36:39], s61 offen lds
    ds_read_b128 v[56:59], v18 offset:0
    ds_read_b128 v[60:63], v19 offset:0
    s_add_u32 m0, s55, 5120
    v_exp_f32 v76, v76
    v_fma_f32 v75, v75, v91, v91
    v_rcp_f32 v74, v74
    v_cvt_pk_bf16_f32 v28, v72, v73
    buffer_load_dwordx4 v9, s[36:39], s61 offen lds
    s_waitcnt lgkmcnt(6)
    ds_read_b128 v[48:51], v16 offset:5232
    ds_read_u16 v52, v53 offset:128
    s_add_u32 m0, s55, 6144
    v_exp_f32 v77, v77
    v_fma_f32 v76, v76, v92, v92
    v_rcp_f32 v75, v75
    buffer_load_dwordx4 v10, s[36:39], s61 offen lds
    s_add_u32 m0, s55, 7168
    v_exp_f32 v78, v78
    v_fma_f32 v77, v77, v93, v93
    v_rcp_f32 v76, v76
    v_cvt_pk_bf16_f32 v29, v74, v75
    buffer_load_dwordx4 v11, s[36:39], s61 offen lds
    v_exp_f32 v79, v79
    v_fma_f32 v78, v78, v94, v94
    v_rcp_f32 v77, v77
    v_fma_f32 v79, v79, v95, v95
    v_rcp_f32 v78, v78
    v_cvt_pk_bf16_f32 v30, v76, v77
    v_rcp_f32 v79, v79
    s_nop 0
    v_cvt_pk_bf16_f32 v31, v78, v79
    s_waitcnt lgkmcnt(0)
    v_mfma_f32_32x32x16_f16 v[64:79], v[32:35], v[248:251], 0
    v_exp_f32 v96, v96
    v_mfma_f32_32x32x16_bf16 v[80:95], v[40:43], v[248:251], 0
    v_exp_f32 v97, v97
    v_fma_f32 v96, v96, v112, v112
    v_mfma_f32_32x32x16_bf16 v[192:207], v[24:27], v[56:59], v[192:207]
    ds_read_u16 v18, v15 offset:256
    ds_read_u16 v19, v15 offset:258
    v_exp_f32 v98, v98
    v_fma_f32 v97, v97, v113, v113
    v_rcp_f32 v96, v96
    v_mfma_f32_32x32x16_f16 v[64:79], v[36:39], v[252:255], v[64:79]
    v_exp_f32 v99, v99
    v_fma_f32 v98, v98, v114, v114
    v_rcp_f32 v97, v97
    v_mfma_f32_32x32x16_bf16 v[80:95], v[44:47], v[252:255], v[80:95]
    v_exp_f32 v100, v100
    v_fma_f32 v99, v99, v115, v115
    v_rcp_f32 v98, v98
    v_cvt_pk_bf16_f32 v24, v96, v97
    v_mfma_f32_32x32x16_bf16 v[192:207], v[28:31], v[60:63], v[192:207]
    s_waitcnt vmcnt(4)
    ds_read_b128 v[32:35], v1 offset:0
    v_exp_f32 v101, v101
    v_fma_f32 v100, v100, v116, v116
    v_rcp_f32 v99, v99
    v_mfma_f32_32x32x16_bf16 v[64:79], v[148:151], v[240:243], v[64:79]
    ds_read_b128 v[36:39], v2 offset:0
    v_exp_f32 v102, v102
    v_fma_f32 v101, v101, v117, v117
    v_rcp_f32 v100, v100
    v_cvt_pk_bf16_f32 v25, v98, v99
    v_smfmac_f32_32x32x32_f16 v[64:79], v[48:51], v[224:231], v52
    ds_read_b128 v[40:43], v3 offset:0
    v_exp_f32 v103, v103
    v_fma_f32 v102, v102, v118, v118
    v_rcp_f32 v101, v101
    ds_read_b128 v[44:47], v4 offset:0
    v_exp_f32 v104, v104
    v_fma_f32 v103, v103, v119, v119
    v_rcp_f32 v102, v102
    v_cvt_pk_bf16_f32 v26, v100, v101
    v_exp_f32 v105, v105
    v_fma_f32 v104, v104, v120, v120
    v_rcp_f32 v103, v103
    v_exp_f32 v106, v106
    v_fma_f32 v105, v105, v121, v121
    v_rcp_f32 v104, v104
    v_cvt_pk_bf16_f32 v27, v102, v103
    s_add_u32 m0, s55, 8192
    v_exp_f32 v107, v107
    v_fma_f32 v106, v106, v122, v122
    v_rcp_f32 v105, v105
    buffer_load_dwordx4 v8, s[36:39], s62 offen lds
    s_add_u32 m0, s55, 9216
    v_exp_f32 v108, v108
    v_fma_f32 v107, v107, v123, v123
    v_rcp_f32 v106, v106
    v_cvt_pk_bf16_f32 v28, v104, v105
    buffer_load_dwordx4 v9, s[36:39], s62 offen lds
    ds_add_rtn_u32 v22, v20, v21
    s_add_u32 m0, s55, 10240
    v_exp_f32 v109, v109
    v_fma_f32 v108, v108, v124, v124
    v_rcp_f32 v107, v107
    buffer_load_dwordx4 v10, s[36:39], s62 offen lds
    s_add_u32 m0, s55, 11264
    v_exp_f32 v110, v110
    v_fma_f32 v109, v109, v125, v125
    v_rcp_f32 v108, v108
    v_cvt_pk_bf16_f32 v29, v106, v107
    buffer_load_dwordx4 v11, s[36:39], s62 offen lds
    v_exp_f32 v111, v111
    v_fma_f32 v110, v110, v126, v126
    v_rcp_f32 v109, v109
    v_fma_f32 v111, v111, v127, v127
    v_rcp_f32 v110, v110
    v_cvt_pk_bf16_f32 v30, v108, v109
    v_rcp_f32 v111, v111
    s_nop 0
    v_cvt_pk_bf16_f32 v31, v110, v111
    s_cmp_eq_u32 s56, 2
    s_cbranch_scc1 K_ST1
    s_waitcnt lgkmcnt(0)
    v_readfirstlane_b32 s64, v22
    v_mfma_f32_32x32x16_f16 v[96:111], v[32:35], v[248:251], 0
    ds_read_b64 v[12:13], v7 offset:192
    v_exp_f32 v64, v64
    s_mul_i32 s64, s64, s69
    s_setprio 0
    s_cmp_ge_i32 s64, 0
    s_cbranch_scc1 F2
    s_setprio 1
F2:
    v_mfma_f32_32x32x16_bf16 v[112:127], v[40:43], v[248:251], 0
    ds_read_u8 v16, v14 offset:256
    v_exp_f32 v65, v65
    v_fma_f32 v64, v64, v80, v80
    v_mfma_f32_32x32x16_bf16 v[208:223], v[24:27], v[56:59], v[208:223]
    v_exp_f32 v66, v66
    v_fma_f32 v65, v65, v81, v81
    v_rcp_f32 v64, v64
    v_mfma_f32_32x32x16_f16 v[96:111], v[36:39], v[252:255], v[96:111]
    v_exp_f32 v67, v67
    v_fma_f32 v66, v66, v82, v82
    v_rcp_f32 v65, v65
    v_mfma_f32_32x32x16_bf16 v[112:127], v[44:47], v[252:255], v[112:127]
    v_exp_f32 v68, v68
    v_fma_f32 v67, v67, v83, v83
    v_rcp_f32 v66, v66
    v_cvt_pk_bf16_f32 v24, v64, v65
    v_mfma_f32_32x32x16_bf16 v[208:223], v[28:31], v[60:63], v[208:223]
    s_waitcnt vmcnt(4)
    ds_read_b128 v[32:35], v1 offset:4096
    v_exp_f32 v69, v69
    v_fma_f32 v68, v68, v84, v84
    v_rcp_f32 v67, v67
    v_mfma_f32_32x32x16_bf16 v[96:111], v[148:151], v[244:247], v[96:111]
    ds_read_b128 v[36:39], v2 offset:4096
    v_exp_f32 v70, v70
    v_fma_f32 v69, v69, v85, v85
    v_rcp_f32 v68, v68
    v_cvt_pk_bf16_f32 v25, v66, v67
    v_smfmac_f32_32x32x32_f16 v[96:111], v[48:51], v[232:239], v52
    ds_read_b128 v[40:43], v3 offset:4096
    v_exp_f32 v71, v71
    v_fma_f32 v70, v70, v86, v86
    v_rcp_f32 v69, v69
    ds_read_b128 v[44:47], v4 offset:4096
    v_exp_f32 v72, v72
    v_fma_f32 v71, v71, v87, v87
    v_rcp_f32 v70, v70
    v_cvt_pk_bf16_f32 v26, v68, v69
    v_exp_f32 v73, v73
    v_fma_f32 v72, v72, v88, v88
    v_rcp_f32 v71, v71
    v_exp_f32 v74, v74
    v_fma_f32 v73, v73, v89, v89
    v_rcp_f32 v72, v72
    v_cvt_pk_bf16_f32 v27, v70, v71
    s_waitcnt lgkmcnt(5)
    v_mad_u32_u16 v8, v12, s60, v5
    v_mad_u32_u16 v9, v12, s60, v6 op_sel:[1,0,0,0]
    v_mad_u32_u16 v10, v13, s60, v5
    v_mad_u32_u16 v11, v13, s60, v6 op_sel:[1,0,0,0]
    s_add_u32 m0, s55, 0
    v_exp_f32 v75, v75
    v_fma_f32 v74, v74, v90, v90
    v_rcp_f32 v73, v73
    buffer_load_dwordx4 v8, s[36:39], s61 offen lds
    ds_read_b128 v[56:59], v18 offset:0
    ds_read_b128 v[60:63], v19 offset:0
    s_add_u32 m0, s55, 1024
    v_exp_f32 v76, v76
    v_fma_f32 v75, v75, v91, v91
    v_rcp_f32 v74, v74
    v_cvt_pk_bf16_f32 v28, v72, v73
    buffer_load_dwordx4 v9, s[36:39], s61 offen lds
    s_waitcnt lgkmcnt(6)
    ds_read_b128 v[48:51], v16 offset:5232
    ds_read_u16 v52, v53 offset:256
    s_add_u32 m0, s55, 2048
    v_exp_f32 v77, v77
    v_fma_f32 v76, v76, v92, v92
    v_rcp_f32 v75, v75
    buffer_load_dwordx4 v10, s[36:39], s61 offen lds
    s_add_u32 m0, s55, 3072
    v_exp_f32 v78, v78
    v_fma_f32 v77, v77, v93, v93
    v_rcp_f32 v76, v76
    v_cvt_pk_bf16_f32 v29, v74, v75
    buffer_load_dwordx4 v11, s[36:39], s61 offen lds
    v_exp_f32 v79, v79
    v_fma_f32 v78, v78, v94, v94
    v_rcp_f32 v77, v77
    v_fma_f32 v79, v79, v95, v95
    v_rcp_f32 v78, v78
    v_cvt_pk_bf16_f32 v30, v76, v77
    v_rcp_f32 v79, v79
    s_nop 0
    v_cvt_pk_bf16_f32 v31, v78, v79
    s_waitcnt lgkmcnt(0)
    v_mfma_f32_32x32x16_f16 v[64:79], v[32:35], v[248:251], 0
    v_exp_f32 v96, v96
    v_mfma_f32_32x32x16_bf16 v[80:95], v[40:43], v[248:251], 0
    v_exp_f32 v97, v97
    v_fma_f32 v96, v96, v112, v112
    v_mfma_f32_32x32x16_bf16 v[192:207], v[24:27], v[56:59], v[192:207]
    ds_read_u16 v18, v15 offset:512
    ds_read_u16 v19, v15 offset:514
    v_exp_f32 v98, v98
    v_fma_f32 v97, v97, v113, v113
    v_rcp_f32 v96, v96
    v_mfma_f32_32x32x16_f16 v[64:79], v[36:39], v[252:255], v[64:79]
    v_exp_f32 v99, v99
    v_fma_f32 v98, v98, v114, v114
    v_rcp_f32 v97, v97
    v_mfma_f32_32x32x16_bf16 v[80:95], v[44:47], v[252:255], v[80:95]
    v_exp_f32 v100, v100
    v_fma_f32 v99, v99, v115, v115
    v_rcp_f32 v98, v98
    v_cvt_pk_bf16_f32 v24, v96, v97
    v_mfma_f32_32x32x16_bf16 v[192:207], v[28:31], v[60:63], v[192:207]
    s_waitcnt vmcnt(4)
    ds_read_b128 v[32:35], v1 offset:8192
    v_exp_f32 v101, v101
    v_fma_f32 v100, v100, v116, v116
    v_rcp_f32 v99, v99
    v_mfma_f32_32x32x16_bf16 v[64:79], v[132:135], v[240:243], v[64:79]
    ds_read_b128 v[36:39], v2 offset:8192
    v_exp_f32 v102, v102
    v_fma_f32 v101, v101, v117, v117
    v_rcp_f32 v100, v100
    v_cvt_pk_bf16_f32 v25, v98, v99
    v_smfmac_f32_32x32x32_f16 v[64:79], v[48:51], v[224:231], v52
    ds_read_b128 v[40:43], v3 offset:8192
    v_exp_f32 v103, v103
    v_fma_f32 v102, v102, v118, v118
    v_rcp_f32 v101, v101
    ds_read_b128 v[44:47], v4 offset:8192
    v_exp_f32 v104, v104
    v_fma_f32 v103, v103, v119, v119
    v_rcp_f32 v102, v102
    v_cvt_pk_bf16_f32 v26, v100, v101
    v_exp_f32 v105, v105
    v_fma_f32 v104, v104, v120, v120
    v_rcp_f32 v103, v103
    v_exp_f32 v106, v106
    v_fma_f32 v105, v105, v121, v121
    v_rcp_f32 v104, v104
    v_cvt_pk_bf16_f32 v27, v102, v103
    s_add_u32 m0, s55, 4096
    v_exp_f32 v107, v107
    v_fma_f32 v106, v106, v122, v122
    v_rcp_f32 v105, v105
    buffer_load_dwordx4 v8, s[36:39], s62 offen lds
    s_add_u32 m0, s55, 5120
    v_exp_f32 v108, v108
    v_fma_f32 v107, v107, v123, v123
    v_rcp_f32 v106, v106
    v_cvt_pk_bf16_f32 v28, v104, v105
    buffer_load_dwordx4 v9, s[36:39], s62 offen lds
    ds_add_rtn_u32 v22, v20, v21
    s_add_u32 m0, s55, 6144
    v_exp_f32 v109, v109
    v_fma_f32 v108, v108, v124, v124
    v_rcp_f32 v107, v107
    buffer_load_dwordx4 v10, s[36:39], s62 offen lds
    s_add_u32 m0, s55, 7168
    v_exp_f32 v110, v110
    v_fma_f32 v109, v109, v125, v125
    v_rcp_f32 v108, v108
    v_cvt_pk_bf16_f32 v29, v106, v107
    buffer_load_dwordx4 v11, s[36:39], s62 offen lds
    v_exp_f32 v111, v111
    v_fma_f32 v110, v110, v126, v126
    v_rcp_f32 v109, v109
    v_fma_f32 v111, v111, v127, v127
    v_rcp_f32 v110, v110
    v_cvt_pk_bf16_f32 v30, v108, v109
    v_rcp_f32 v111, v111
    s_nop 0
    v_cvt_pk_bf16_f32 v31, v110, v111
    s_cmp_eq_u32 s56, 3
    s_cbranch_scc1 K_ST2
    s_waitcnt lgkmcnt(0)
    v_readfirstlane_b32 s64, v22
    v_mfma_f32_32x32x16_f16 v[96:111], v[32:35], v[248:251], 0
    ds_read_b64 v[12:13], v7 offset:256
    v_exp_f32 v64, v64
    s_mul_i32 s64, s64, s69
    s_setprio 0
    s_cmp_ge_i32 s64, 0
    s_cbranch_scc1 F4
    s_setprio 1
F4:
    v_mfma_f32_32x32x16_bf16 v[112:127], v[40:43], v[248:251], 0
    ds_read_u8 v16, v14 offset:384
    v_exp_f32 v65, v65
    v_fma_f32 v64, v64, v80, v80
    v_mfma_f32_32x32x16_bf16 v[208:223], v[24:27], v[56:59], v[208:223]
    v_exp_f32 v66, v66
    v_fma_f32 v65, v65, v81, v81
    v_rcp_f32 v64, v64
    v_mfma_f32_32x32x16_f16 v[96:111], v[36:39], v[252:255], v[96:111]
    v_exp_f32 v67, v67
    v_fma_f32 v66, v66, v82, v82
    v_rcp_f32 v65, v65
    v_mfma_f32_32x32x16_bf16 v[112:127], v[44:47], v[252:255], v[112:127]
    v_exp_f32 v68, v68
    v_fma_f32 v67, v67, v83, v83
    v_rcp_f32 v66, v66
    v_cvt_pk_bf16_f32 v24, v64, v65
    v_mfma_f32_32x32x16_bf16 v[208:223], v[28:31], v[60:63], v[208:223]
    s_waitcnt vmcnt(4)
    ds_read_b128 v[32:35], v1 offset:0
    v_exp_f32 v69, v69
    v_fma_f32 v68, v68, v84, v84
    v_rcp_f32 v67, v67
    v_mfma_f32_32x32x16_bf16 v[96:111], v[132:135], v[244:247], v[96:111]
    ds_read_b128 v[36:39], v2 offset:0
    v_exp_f32 v70, v70
    v_fma_f32 v69, v69, v85, v85
    v_rcp_f32 v68, v68
    v_cvt_pk_bf16_f32 v25, v66, v67
    v_smfmac_f32_32x32x32_f16 v[96:111], v[48:51], v[232:239], v52
    ds_read_b128 v[40:43], v3 offset:0
    v_exp_f32 v71, v71
    v_fma_f32 v70, v70, v86, v86
    v_rcp_f32 v69, v69
    ds_read_b128 v[44:47], v4 offset:0
    v_exp_f32 v72, v72
    v_fma_f32 v71, v71, v87, v87
    v_rcp_f32 v70, v70
    v_cvt_pk_bf16_f32 v26, v68, v69
    v_exp_f32 v73, v73
    v_fma_f32 v72, v72, v88, v88
    v_rcp_f32 v71, v71
    v_exp_f32 v74, v74
    v_fma_f32 v73, v73, v89, v89
    v_rcp_f32 v72, v72
    v_cvt_pk_bf16_f32 v27, v70, v71
    s_waitcnt lgkmcnt(5)
    v_mad_u32_u16 v8, v12, s60, v5
    v_mad_u32_u16 v9, v12, s60, v6 op_sel:[1,0,0,0]
    v_mad_u32_u16 v10, v13, s60, v5
    v_mad_u32_u16 v11, v13, s60, v6 op_sel:[1,0,0,0]
    s_add_u32 m0, s55, 8192
    v_exp_f32 v75, v75
    v_fma_f32 v74, v74, v90, v90
    v_rcp_f32 v73, v73
    buffer_load_dwordx4 v8, s[36:39], s61 offen lds
    ds_read_b128 v[56:59], v18 offset:0
    ds_read_b128 v[60:63], v19 offset:0
    s_add_u32 m0, s55, 9216
    v_exp_f32 v76, v76
    v_fma_f32 v75, v75, v91, v91
    v_rcp_f32 v74, v74
    v_cvt_pk_bf16_f32 v28, v72, v73
    buffer_load_dwordx4 v9, s[36:39], s61 offen lds
    s_waitcnt lgkmcnt(6)
    ds_read_b128 v[48:51], v16 offset:5232
    ds_read_u16 v52, v53 offset:384
    s_add_u32 m0, s55, 10240
    v_exp_f32 v77, v77
    v_fma_f32 v76, v76, v92, v92
    v_rcp_f32 v75, v75
    buffer_load_dwordx4 v10, s[36:39], s61 offen lds
    s_add_u32 m0, s55, 11264
    v_exp_f32 v78, v78
    v_fma_f32 v77, v77, v93, v93
    v_rcp_f32 v76, v76
    v_cvt_pk_bf16_f32 v29, v74, v75
    buffer_load_dwordx4 v11, s[36:39], s61 offen lds
    v_exp_f32 v79, v79
    v_fma_f32 v78, v78, v94, v94
    v_rcp_f32 v77, v77
    v_fma_f32 v79, v79, v95, v95
    v_rcp_f32 v78, v78
    v_cvt_pk_bf16_f32 v30, v76, v77
    v_rcp_f32 v79, v79
    s_nop 0
    v_cvt_pk_bf16_f32 v31, v78, v79
    s_waitcnt lgkmcnt(0)
    v_mfma_f32_32x32x16_f16 v[64:79], v[32:35], v[248:251], 0
    v_exp_f32 v96, v96
    v_mfma_f32_32x32x16_bf16 v[80:95], v[40:43], v[248:251], 0
    v_exp_f32 v97, v97
    v_fma_f32 v96, v96, v112, v112
    v_mfma_f32_32x32x16_bf16 v[192:207], v[24:27], v[56:59], v[192:207]
    ds_read_u16 v18, v15 offset:768
    ds_read_u16 v19, v15 offset:770
    v_exp_f32 v98, v98
    v_fma_f32 v97, v97, v113, v113
    v_rcp_f32 v96, v96
    v_mfma_f32_32x32x16_f16 v[64:79], v[36:39], v[252:255], v[64:79]
    v_exp_f32 v99, v99
    v_fma_f32 v98, v98, v114, v114
    v_rcp_f32 v97, v97
    v_mfma_f32_32x32x16_bf16 v[80:95], v[44:47], v[252:255], v[80:95]
    v_exp_f32 v100, v100
    v_fma_f32 v99, v99, v115, v115
    v_rcp_f32 v98, v98
    v_cvt_pk_bf16_f32 v24, v96, v97
    v_mfma_f32_32x32x16_bf16 v[192:207], v[28:31], v[60:63], v[192:207]
    s_waitcnt vmcnt(4)
    ds_read_b128 v[32:35], v1 offset:4096
    v_exp_f32 v101, v101
    v_fma_f32 v100, v100, v116, v116
    v_rcp_f32 v99, v99
    v_mfma_f32_32x32x16_bf16 v[64:79], v[152:155], v[240:243], v[64:79]
    ds_read_b128 v[36:39], v2 offset:4096
    v_exp_f32 v102, v102
    v_fma_f32 v101, v101, v117, v117
    v_rcp_f32 v100, v100
    v_cvt_pk_bf16_f32 v25, v98, v99
    v_smfmac_f32_32x32x32_f16 v[64:79], v[48:51], v[224:231], v52
    ds_read_b128 v[40:43], v3 offset:4096
    v_exp_f32 v103, v103
    v_fma_f32 v102, v102, v118, v118
    v_rcp_f32 v101, v101
    ds_read_b128 v[44:47], v4 offset:4096
    v_exp_f32 v104, v104
    v_fma_f32 v103, v103, v119, v119
    v_rcp_f32 v102, v102
    v_cvt_pk_bf16_f32 v26, v100, v101
    v_exp_f32 v105, v105
    v_fma_f32 v104, v104, v120, v120
    v_rcp_f32 v103, v103
    v_exp_f32 v106, v106
    v_fma_f32 v105, v105, v121, v121
    v_rcp_f32 v104, v104
    v_cvt_pk_bf16_f32 v27, v102, v103
    s_add_u32 m0, s55, 0
    v_exp_f32 v107, v107
    v_fma_f32 v106, v106, v122, v122
    v_rcp_f32 v105, v105
    buffer_load_dwordx4 v8, s[36:39], s62 offen lds
    s_add_u32 m0, s55, 1024
    v_exp_f32 v108, v108
    v_fma_f32 v107, v107, v123, v123
    v_rcp_f32 v106, v106
    v_cvt_pk_bf16_f32 v28, v104, v105
    buffer_load_dwordx4 v9, s[36:39], s62 offen lds
    ds_add_rtn_u32 v22, v20, v21
    s_add_u32 m0, s55, 2048
    v_exp_f32 v109, v109
    v_fma_f32 v108, v108, v124, v124
    v_rcp_f32 v107, v107
    buffer_load_dwordx4 v10, s[36:39], s62 offen lds
    s_add_u32 m0, s55, 3072
    v_exp_f32 v110, v110
    v_fma_f32 v109, v109, v125, v125
    v_rcp_f32 v108, v108
    v_cvt_pk_bf16_f32 v29, v106, v107
    buffer_load_dwordx4 v11, s[36:39], s62 offen lds
    v_exp_f32 v111, v111
    v_fma_f32 v110, v110, v126, v126
    v_rcp_f32 v109, v109
    v_fma_f32 v111, v111, v127, v127
    v_rcp_f32 v110, v110
    v_cvt_pk_bf16_f32 v30, v108, v109
    v_rcp_f32 v111, v111
    s_nop 0
    v_cvt_pk_bf16_f32 v31, v110, v111
    s_cmp_eq_u32 s56, 4
    s_cbranch_scc1 K_ST3
    s_waitcnt lgkmcnt(0)
    v_readfirstlane_b32 s64, v22
    v_mfma_f32_32x32x16_f16 v[96:111], v[32:35], v[248:251], 0
    ds_read_b64 v[12:13], v7 offset:320
    v_exp_f32 v64, v64
    s_mul_i32 s64, s64, s69
    s_setprio 0
    s_cmp_ge_i32 s64, 0
    s_cbranch_scc1 F6
    s_setprio 1
F6:
    v_mfma_f32_32x32x16_bf16 v[112:127], v[40:43], v[248:251], 0
    ds_read_u8 v16, v14 offset:512
    v_exp_f32 v65, v65
    v_fma_f32 v64, v64, v80, v80
    v_mfma_f32_32x32x16_bf16 v[208:223], v[24:27], v[56:59], v[208:223]
    v_exp_f32 v66, v66
    v_fma_f32 v65, v65, v81, v81
    v_rcp_f32 v64, v64
    v_mfma_f32_32x32x16_f16 v[96:111], v[36:39], v[252:255], v[96:111]
    v_exp_f32 v67, v67
    v_fma_f32 v66, v66, v82, v82
    v_rcp_f32 v65, v65
    v_mfma_f32_32x32x16_bf16 v[112:127], v[44:47], v[252:255], v[112:127]
    v_exp_f32 v68, v68
    v_fma_f32 v67, v67, v83, v83
    v_rcp_f32 v66, v66
    v_cvt_pk_bf16_f32 v24, v64, v65
    v_mfma_f32_32x32x16_bf16 v[208:223], v[28:31], v[60:63], v[208:223]
    s_waitcnt vmcnt(4)
    ds_read_b128 v[32:35], v1 offset:8192
    v_exp_f32 v69, v69
    v_fma_f32 v68, v68, v84, v84
    v_rcp_f32 v67, v67
    v_mfma_f32_32x32x16_bf16 v[96:111], v[152:155], v[244:247], v[96:111]
    ds_read_b128 v[36:39], v2 offset:8192
    v_exp_f32 v70, v70
    v_fma_f32 v69, v69, v85, v85
    v_rcp_f32 v68, v68
    v_cvt_pk_bf16_f32 v25, v66, v67
    v_smfmac_f32_32x32x32_f16 v[96:111], v[48:51], v[232:239], v52
    ds_read_b128 v[40:43], v3 offset:8192
    v_exp_f32 v71, v71
    v_fma_f32 v70, v70, v86, v86
    v_rcp_f32 v69, v69
    ds_read_b128 v[44:47], v4 offset:8192
    v_exp_f32 v72, v72
    v_fma_f32 v71, v71, v87, v87
    v_rcp_f32 v70, v70
    v_cvt_pk_bf16_f32 v26, v68, v69
    v_exp_f32 v73, v73
    v_fma_f32 v72, v72, v88, v88
    v_rcp_f32 v71, v71
    v_exp_f32 v74, v74
    v_fma_f32 v73, v73, v89, v89
    v_rcp_f32 v72, v72
    v_cvt_pk_bf16_f32 v27, v70, v71
    s_waitcnt lgkmcnt(5)
    v_mad_u32_u16 v8, v12, s60, v5
    v_mad_u32_u16 v9, v12, s60, v6 op_sel:[1,0,0,0]
    v_mad_u32_u16 v10, v13, s60, v5
    v_mad_u32_u16 v11, v13, s60, v6 op_sel:[1,0,0,0]
    s_add_u32 m0, s55, 4096
    v_exp_f32 v75, v75
    v_fma_f32 v74, v74, v90, v90
    v_rcp_f32 v73, v73
    buffer_load_dwordx4 v8, s[36:39], s61 offen lds
    ds_read_b128 v[56:59], v18 offset:0
    ds_read_b128 v[60:63], v19 offset:0
    s_add_u32 m0, s55, 5120
    v_exp_f32 v76, v76
    v_fma_f32 v75, v75, v91, v91
    v_rcp_f32 v74, v74
    v_cvt_pk_bf16_f32 v28, v72, v73
    buffer_load_dwordx4 v9, s[36:39], s61 offen lds
    s_waitcnt lgkmcnt(6)
    ds_read_b128 v[48:51], v16 offset:5232
    ds_read_u16 v52, v53 offset:512
    s_add_u32 m0, s55, 6144
    v_exp_f32 v77, v77
    v_fma_f32 v76, v76, v92, v92
    v_rcp_f32 v75, v75
    buffer_load_dwordx4 v10, s[36:39], s61 offen lds
    s_add_u32 m0, s55, 7168
    v_exp_f32 v78, v78
    v_fma_f32 v77, v77, v93, v93
    v_rcp_f32 v76, v76
    v_cvt_pk_bf16_f32 v29, v74, v75
    buffer_load_dwordx4 v11, s[36:39], s61 offen lds
    v_exp_f32 v79, v79
    v_fma_f32 v78, v78, v94, v94
    v_rcp_f32 v77, v77
    v_fma_f32 v79, v79, v95, v95
    v_rcp_f32 v78, v78
    v_cvt_pk_bf16_f32 v30, v76, v77
    v_rcp_f32 v79, v79
    s_nop 0
    v_cvt_pk_bf16_f32 v31, v78, v79
    s_waitcnt lgkmcnt(0)
    v_mfma_f32_32x32x16_f16 v[64:79], v[32:35], v[248:251], 0
    v_exp_f32 v96, v96
    v_mfma_f32_32x32x16_bf16 v[80:95], v[40:43], v[248:251], 0
    v_exp_f32 v97, v97
    v_fma_f32 v96, v96, v112, v112
    v_mfma_f32_32x32x16_bf16 v[192:207], v[24:27], v[56:59], v[192:207]
    ds_read_u16 v18, v15 offset:1024
    ds_read_u16 v19, v15 offset:1026
    v_exp_f32 v98, v98
    v_fma_f32 v97, v97, v113, v113
    v_rcp_f32 v96, v96
    v_mfma_f32_32x32x16_f16 v[64:79], v[36:39], v[252:255], v[64:79]
    v_exp_f32 v99, v99
    v_fma_f32 v98, v98, v114, v114
    v_rcp_f32 v97, v97
    v_mfma_f32_32x32x16_bf16 v[80:95], v[44:47], v[252:255], v[80:95]
    v_exp_f32 v100, v100
    v_fma_f32 v99, v99, v115, v115
    v_rcp_f32 v98, v98
    v_cvt_pk_bf16_f32 v24, v96, v97
    v_mfma_f32_32x32x16_bf16 v[192:207], v[28:31], v[60:63], v[192:207]
    s_waitcnt vmcnt(4)
    ds_read_b128 v[32:35], v1 offset:0
    v_exp_f32 v101, v101
    v_fma_f32 v100, v100, v116, v116
    v_rcp_f32 v99, v99
    v_mfma_f32_32x32x16_bf16 v[64:79], v[136:139], v[240:243], v[64:79]
    ds_read_b128 v[36:39], v2 offset:0
    v_exp_f32 v102, v102
    v_fma_f32 v101, v101, v117, v117
    v_rcp_f32 v100, v100
    v_cvt_pk_bf16_f32 v25, v98, v99
    v_smfmac_f32_32x32x32_f16 v[64:79], v[48:51], v[224:231], v52
    ds_read_b128 v[40:43], v3 offset:0
    v_exp_f32 v103, v103
    v_fma_f32 v102, v102, v118, v118
    v_rcp_f32 v101, v101
    ds_read_b128 v[44:47], v4 offset:0
    v_exp_f32 v104, v104
    v_fma_f32 v103, v103, v119, v119
    v_rcp_f32 v102, v102
    v_cvt_pk_bf16_f32 v26, v100, v101
    v_exp_f32 v105, v105
    v_fma_f32 v104, v104, v120, v120
    v_rcp_f32 v103, v103
    v_exp_f32 v106, v106
    v_fma_f32 v105, v105, v121, v121
    v_rcp_f32 v104, v104
    v_cvt_pk_bf16_f32 v27, v102, v103
    s_add_u32 m0, s55, 8192
    v_exp_f32 v107, v107
    v_fma_f32 v106, v106, v122, v122
    v_rcp_f32 v105, v105
    buffer_load_dwordx4 v8, s[36:39], s62 offen lds
    s_add_u32 m0, s55, 9216
    v_exp_f32 v108, v108
    v_fma_f32 v107, v107, v123, v123
    v_rcp_f32 v106, v106
    v_cvt_pk_bf16_f32 v28, v104, v105
    buffer_load_dwordx4 v9, s[36:39], s62 offen lds
    ds_add_rtn_u32 v22, v20, v21
    s_add_u32 m0, s55, 10240
    v_exp_f32 v109, v109
    v_fma_f32 v108, v108, v124, v124
    v_rcp_f32 v107, v107
    buffer_load_dwordx4 v10, s[36:39], s62 offen lds
    s_add_u32 m0, s55, 11264
    v_exp_f32 v110, v110
    v_fma_f32 v109, v109, v125, v125
    v_rcp_f32 v108, v108
    v_cvt_pk_bf16_f32 v29, v106, v107
    buffer_load_dwordx4 v11, s[36:39], s62 offen lds
    v_exp_f32 v111, v111
    v_fma_f32 v110, v110, v126, v126
    v_rcp_f32 v109, v109
    v_fma_f32 v111, v111, v127, v127
    v_rcp_f32 v110, v110
    v_cvt_pk_bf16_f32 v30, v108, v109
    v_rcp_f32 v111, v111
    s_nop 0
    v_cvt_pk_bf16_f32 v31, v110, v111
    s_cmp_eq_u32 s56, 5
    s_cbranch_scc1 K_ST4
    s_waitcnt lgkmcnt(0)
    v_readfirstlane_b32 s64, v22
    v_mfma_f32_32x32x16_f16 v[96:111], v[32:35], v[248:251], 0
    ds_read_b64 v[12:13], v7 offset:384
    v_exp_f32 v64, v64
    s_mul_i32 s64, s64, s69
    s_setprio 0
    s_cmp_ge_i32 s64, 0
    s_cbranch_scc1 F8
    s_setprio 1
F8:
    v_mfma_f32_32x32x16_bf16 v[112:127], v[40:43], v[248:251], 0
    ds_read_u8 v16, v14 offset:640
    v_exp_f32 v65, v65
    v_fma_f32 v64, v64, v80, v80
    v_mfma_f32_32x32x16_bf16 v[208:223], v[24:27], v[56:59], v[208:223]
    v_exp_f32 v66, v66
    v_fma_f32 v65, v65, v81, v81
    v_rcp_f32 v64, v64
    v_mfma_f32_32x32x16_f16 v[96:111], v[36:39], v[252:255], v[96:111]
    v_exp_f32 v67, v67
    v_fma_f32 v66, v66, v82, v82
    v_rcp_f32 v65, v65
    v_mfma_f32_32x32x16_bf16 v[112:127], v[44:47], v[252:255], v[112:127]
    v_exp_f32 v68, v68
    v_fma_f32 v67, v67, v83, v83
    v_rcp_f32 v66, v66
    v_cvt_pk_bf16_f32 v24, v64, v65
    v_mfma_f32_32x32x16_bf16 v[208:223], v[28:31], v[60:63], v[208:223]
    s_waitcnt vmcnt(4)
    ds_read_b128 v[32:35], v1 offset:4096
    v_exp_f32 v69, v69
    v_fma_f32 v68, v68, v84, v84
    v_rcp_f32 v67, v67
    v_mfma_f32_32x32x16_bf16 v[96:111], v[136:139], v[244:247], v[96:111]
    ds_read_b128 v[36:39], v2 offset:4096
    v_exp_f32 v70, v70
    v_fma_f32 v69, v69, v85, v85
    v_rcp_f32 v68, v68
    v_cvt_pk_bf16_f32 v25, v66, v67
    v_smfmac_f32_32x32x32_f16 v[96:111], v[48:51], v[232:239], v52
    ds_read_b128 v[40:43], v3 offset:4096
    v_exp_f32 v71, v71
    v_fma_f32 v70, v70, v86, v86
    v_rcp_f32 v69, v69
    ds_read_b128 v[44:47], v4 offset:4096
    v_exp_f32 v72, v72
    v_fma_f32 v71, v71, v87, v87
    v_rcp_f32 v70, v70
    v_cvt_pk_bf16_f32 v26, v68, v69
    v_exp_f32 v73, v73
    v_fma_f32 v72, v72, v88, v88
    v_rcp_f32 v71, v71
    v_exp_f32 v74, v74
    v_fma_f32 v73, v73, v89, v89
    v_rcp_f32 v72, v72
    v_cvt_pk_bf16_f32 v27, v70, v71
    s_waitcnt lgkmcnt(5)
    v_mad_u32_u16 v8, v12, s60, v5
    v_mad_u32_u16 v9, v12, s60, v6 op_sel:[1,0,0,0]
    v_mad_u32_u16 v10, v13, s60, v5
    v_mad_u32_u16 v11, v13, s60, v6 op_sel:[1,0,0,0]
    s_add_u32 m0, s55, 0
    v_exp_f32 v75, v75
    v_fma_f32 v74, v74, v90, v90
    v_rcp_f32 v73, v73
    buffer_load_dwordx4 v8, s[36:39], s61 offen lds
    ds_read_b128 v[56:59], v18 offset:0
    ds_read_b128 v[60:63], v19 offset:0
    s_add_u32 m0, s55, 1024
    v_exp_f32 v76, v76
    v_fma_f32 v75, v75, v91, v91
    v_rcp_f32 v74, v74
    v_cvt_pk_bf16_f32 v28, v72, v73
    buffer_load_dwordx4 v9, s[36:39], s61 offen lds
    s_waitcnt lgkmcnt(6)
    ds_read_b128 v[48:51], v16 offset:5232
    ds_read_u16 v52, v53 offset:640
    s_add_u32 m0, s55, 2048
    v_exp_f32 v77, v77
    v_fma_f32 v76, v76, v92, v92
    v_rcp_f32 v75, v75
    buffer_load_dwordx4 v10, s[36:39], s61 offen lds
    s_add_u32 m0, s55, 3072
    v_exp_f32 v78, v78
    v_fma_f32 v77, v77, v93, v93
    v_rcp_f32 v76, v76
    v_cvt_pk_bf16_f32 v29, v74, v75
    buffer_load_dwordx4 v11, s[36:39], s61 offen lds
    v_exp_f32 v79, v79
    v_fma_f32 v78, v78, v94, v94
    v_rcp_f32 v77, v77
    v_fma_f32 v79, v79, v95, v95
    v_rcp_f32 v78, v78
    v_cvt_pk_bf16_f32 v30, v76, v77
    v_rcp_f32 v79, v79
    s_nop 0
    v_cvt_pk_bf16_f32 v31, v78, v79
    s_waitcnt lgkmcnt(0)
    v_mfma_f32_32x32x16_f16 v[64:79], v[32:35], v[248:251], 0
    v_exp_f32 v96, v96
    v_mfma_f32_32x32x16_bf16 v[80:95], v[40:43], v[248:251], 0
    v_exp_f32 v97, v97
    v_fma_f32 v96, v96, v112, v112
    v_mfma_f32_32x32x16_bf16 v[192:207], v[24:27], v[56:59], v[192:207]
    ds_read_u16 v18, v15 offset:1280
    ds_read_u16 v19, v15 offset:1282
    v_exp_f32 v98, v98
    v_fma_f32 v97, v97, v113, v113
    v_rcp_f32 v96, v96
    v_mfma_f32_32x32x16_f16 v[64:79], v[36:39], v[252:255], v[64:79]
    v_exp_f32 v99, v99
    v_fma_f32 v98, v98, v114, v114
    v_rcp_f32 v97, v97
    v_mfma_f32_32x32x16_bf16 v[80:95], v[44:47], v[252:255], v[80:95]
    v_exp_f32 v100, v100
    v_fma_f32 v99, v99, v115, v115
    v_rcp_f32 v98, v98
    v_cvt_pk_bf16_f32 v24, v96, v97
    v_mfma_f32_32x32x16_bf16 v[192:207], v[28:31], v[60:63], v[192:207]
    s_waitcnt vmcnt(4)
    ds_read_b128 v[32:35], v1 offset:8192
    v_exp_f32 v101, v101
    v_fma_f32 v100, v100, v116, v116
    v_rcp_f32 v99, v99
    v_mfma_f32_32x32x16_bf16 v[64:79], v[156:159], v[240:243], v[64:79]
    ds_read_b128 v[36:39], v2 offset:8192
    v_exp_f32 v102, v102
    v_fma_f32 v101, v101, v117, v117
    v_rcp_f32 v100, v100
    v_cvt_pk_bf16_f32 v25, v98, v99
    v_smfmac_f32_32x32x32_f16 v[64:79], v[48:51], v[224:231], v52
    ds_read_b128 v[40:43], v3 offset:8192
    v_exp_f32 v103, v103
    v_fma_f32 v102, v102, v118, v118
    v_rcp_f32 v101, v101
    ds_read_b128 v[44:47], v4 offset:8192
    v_exp_f32 v104, v104
    v_fma_f32 v103, v103, v119, v119
    v_rcp_f32 v102, v102
    v_cvt_pk_bf16_f32 v26, v100, v101
    v_exp_f32 v105, v105
    v_fma_f32 v104, v104, v120, v120
    v_rcp_f32 v103, v103
    v_exp_f32 v106, v106
    v_fma_f32 v105, v105, v121, v121
    v_rcp_f32 v104, v104
    v_cvt_pk_bf16_f32 v27, v102, v103
    s_add_u32 m0, s55, 4096
    v_exp_f32 v107, v107
    v_fma_f32 v106, v106, v122, v122
    v_rcp_f32 v105, v105
    buffer_load_dwordx4 v8, s[36:39], s62 offen lds
    s_add_u32 m0, s55, 5120
    v_exp_f32 v108, v108
    v_fma_f32 v107, v107, v123, v123
    v_rcp_f32 v106, v106
    v_cvt_pk_bf16_f32 v28, v104, v105
    buffer_load_dwordx4 v9, s[36:39], s62 offen lds
    ds_add_rtn_u32 v22, v20, v21
    s_add_u32 m0, s55, 6144
    v_exp_f32 v109, v109
    v_fma_f32 v108, v108, v124, v124
    v_rcp_f32 v107, v107
    buffer_load_dwordx4 v10, s[36:39], s62 offen lds
    s_add_u32 m0, s55, 7168
    v_exp_f32 v110, v110
    v_fma_f32 v109, v109, v125, v125
    v_rcp_f32 v108, v108
    v_cvt_pk_bf16_f32 v29, v106, v107
    buffer_load_dwordx4 v11, s[36:39], s62 offen lds
    v_exp_f32 v111, v111
    v_fma_f32 v110, v110, v126, v126
    v_rcp_f32 v109, v109
    v_fma_f32 v111, v111, v127, v127
    v_rcp_f32 v110, v110
    v_cvt_pk_bf16_f32 v30, v108, v109
    v_rcp_f32 v111, v111
    s_nop 0
    v_cvt_pk_bf16_f32 v31, v110, v111
    s_cmp_eq_u32 s56, 6
    s_cbranch_scc1 K_ST5
    s_waitcnt lgkmcnt(0)
    v_readfirstlane_b32 s64, v22
    v_mfma_f32_32x32x16_f16 v[96:111], v[32:35], v[248:251], 0
    ds_read_b64 v[12:13], v7 offset:448
    v_exp_f32 v64, v64
    s_mul_i32 s64, s64, s69
    s_setprio 0
    s_cmp_ge_i32 s64, 0
    s_cbranch_scc1 F10
    s_setprio 1
F10:
    v_mfma_f32_32x32x16_bf16 v[112:127], v[40:43], v[248:251], 0
    ds_read_u8 v16, v14 offset:768
    v_exp_f32 v65, v65
    v_fma_f32 v64, v64, v80, v80
    v_mfma_f32_32x32x16_bf16 v[208:223], v[24:27], v[56:59], v[208:223]
    v_exp_f32 v66, v66
    v_fma_f32 v65, v65, v81, v81
    v_rcp_f32 v64, v64
    v_mfma_f32_32x32x16_f16 v[96:111], v[36:39], v[252:255], v[96:111]
    v_exp_f32 v67, v67
    v_fma_f32 v66, v66, v82, v82
    v_rcp_f32 v65, v65
    v_mfma_f32_32x32x16_bf16 v[112:127], v[44:47], v[252:255], v[112:127]
    v_exp_f32 v68, v68
    v_fma_f32 v67, v67, v83, v83
    v_rcp_f32 v66, v66
    v_cvt_pk_bf16_f32 v24, v64, v65
    v_mfma_f32_32x32x16_bf16 v[208:223], v[28:31], v[60:63], v[208:223]
    s_waitcnt vmcnt(4)
    ds_read_b128 v[32:35], v1 offset:0
    v_exp_f32 v69, v69
    v_fma_f32 v68, v68, v84, v84
    v_rcp_f32 v67, v67
    v_mfma_f32_32x32x16_bf16 v[96:111], v[156:159], v[244:247], v[96:111]
    ds_read_b128 v[36:39], v2 offset:0
    v_exp_f32 v70, v70
    v_fma_f32 v69, v69, v85, v85
    v_rcp_f32 v68, v68
    v_cvt_pk_bf16_f32 v25, v66, v67
    v_smfmac_f32_32x32x32_f16 v[96:111], v[48:51], v[232:239], v52
    ds_read_b128 v[40:43], v3 offset:0
    v_exp_f32 v71, v71
    v_fma_f32 v70, v70, v86, v86
    v_rcp_f32 v69, v69
    ds_read_b128 v[44:47], v4 offset:0
    v_exp_f32 v72, v72
    v_fma_f32 v71, v71, v87, v87
    v_rcp_f32 v70, v70
    v_cvt_pk_bf16_f32 v26, v68, v69
    v_exp_f32 v73, v73
    v_fma_f32 v72, v72, v88, v88
    v_rcp_f32 v71, v71
    v_exp_f32 v74, v74
    v_fma_f32 v73, v73, v89, v89
    v_rcp_f32 v72, v72
    v_cvt_pk_bf16_f32 v27, v70, v71
    s_waitcnt lgkmcnt(5)
    v_mad_u32_u16 v8, v12, s60, v5
    v_mad_u32_u16 v9, v12, s60, v6 op_sel:[1,0,0,0]
    v_mad_u32_u16 v10, v13, s60, v5
    v_mad_u32_u16 v11, v13, s60, v6 op_sel:[1,0,0,0]
    s_add_u32 m0, s55, 8192
    v_exp_f32 v75, v75
    v_fma_f32 v74, v74, v90, v90
    v_rcp_f32 v73, v73
    buffer_load_dwordx4 v8, s[36:39], s61 offen lds
    ds_read_b128 v[56:59], v18 offset:0
    ds_read_b128 v[60:63], v19 offset:0
    s_add_u32 m0, s55, 9216
    v_exp_f32 v76, v76
    v_fma_f32 v75, v75, v91, v91
    v_rcp_f32 v74, v74
    v_cvt_pk_bf16_f32 v28, v72, v73
    buffer_load_dwordx4 v9, s[36:39], s61 offen lds
    s_waitcnt lgkmcnt(6)
    ds_read_b128 v[48:51], v16 offset:5232
    ds_read_u16 v52, v53 offset:768
    s_add_u32 m0, s55, 10240
    v_exp_f32 v77, v77
    v_fma_f32 v76, v76, v92, v92
    v_rcp_f32 v75, v75
    buffer_load_dwordx4 v10, s[36:39], s61 offen lds
    s_add_u32 m0, s55, 11264
    v_exp_f32 v78, v78
    v_fma_f32 v77, v77, v93, v93
    v_rcp_f32 v76, v76
    v_cvt_pk_bf16_f32 v29, v74, v75
    buffer_load_dwordx4 v11, s[36:39], s61 offen lds
    v_exp_f32 v79, v79
    v_fma_f32 v78, v78, v94, v94
    v_rcp_f32 v77, v77
    v_fma_f32 v79, v79, v95, v95
    v_rcp_f32 v78, v78
    v_cvt_pk_bf16_f32 v30, v76, v77
    v_rcp_f32 v79, v79
    s_nop 0
    v_cvt_pk_bf16_f32 v31, v78, v79
    s_waitcnt lgkmcnt(0)
    v_mfma_f32_32x32x16_f16 v[64:79], v[32:35], v[248:251], 0
    v_exp_f32 v96, v96
    v_mfma_f32_32x32x16_bf16 v[80:95], v[40:43], v[248:251], 0
    v_exp_f32 v97, v97
    v_fma_f32 v96, v96, v112, v112
    v_mfma_f32_32x32x16_bf16 v[192:207], v[24:27], v[56:59], v[192:207]
    ds_read_u16 v18, v15 offset:1536
    ds_read_u16 v19, v15 offset:1538
    v_exp_f32 v98, v98
    v_fma_f32 v97, v97, v113, v113
    v_rcp_f32 v96, v96
    v_mfma_f32_32x32x16_f16 v[64:79], v[36:39], v[252:255], v[64:79]
    v_exp_f32 v99, v99
    v_fma_f32 v98, v98, v114, v114
    v_rcp_f32 v97, v97
    v_mfma_f32_32x32x16_bf16 v[80:95], v[44:47], v[252:255], v[80:95]
    v_exp_f32 v100, v100
    v_fma_f32 v99, v99, v115, v115
    v_rcp_f32 v98, v98
    v_cvt_pk_bf16_f32 v24, v96, v97
    v_mfma_f32_32x32x16_bf16 v[192:207], v[28:31], v[60:63], v[192:207]
    s_waitcnt vmcnt(4)
    ds_read_b128 v[32:35], v1 offset:4096
    v_exp_f32 v101, v101
    v_fma_f32 v100, v100, v116, v116
    v_rcp_f32 v99, v99
    v_mfma_f32_32x32x16_bf16 v[64:79], v[140:143], v[240:243], v[64:79]
    ds_read_b128 v[36:39], v2 offset:4096
    v_exp_f32 v102, v102
    v_fma_f32 v101, v101, v117, v117
    v_rcp_f32 v100, v100
    v_cvt_pk_bf16_f32 v25, v98, v99
    v_smfmac_f32_32x32x32_f16 v[64:79], v[48:51], v[224:231], v52
    ds_read_b128 v[40:43], v3 offset:4096
    v_exp_f32 v103, v103
    v_fma_f32 v102, v102, v118, v118
    v_rcp_f32 v101, v101
    ds_read_b128 v[44:47], v4 offset:4096
    v_exp_f32 v104, v104
    v_fma_f32 v103, v103, v119, v119
    v_rcp_f32 v102, v102
    v_cvt_pk_bf16_f32 v26, v100, v101
    v_exp_f32 v105, v105
    v_fma_f32 v104, v104, v120, v120
    v_rcp_f32 v103, v103
    v_exp_f32 v106, v106
    v_fma_f32 v105, v105, v121, v121
    v_rcp_f32 v104, v104
    v_cvt_pk_bf16_f32 v27, v102, v103
    s_add_u32 m0, s55, 0
    v_exp_f32 v107, v107
    v_fma_f32 v106, v106, v122, v122
    v_rcp_f32 v105, v105
    buffer_load_dwordx4 v8, s[36:39], s62 offen lds
    s_add_u32 m0, s55, 1024
    v_exp_f32 v108, v108
    v_fma_f32 v107, v107, v123, v123
    v_rcp_f32 v106, v106
    v_cvt_pk_bf16_f32 v28, v104, v105
    buffer_load_dwordx4 v9, s[36:39], s62 offen lds
    ds_add_rtn_u32 v22, v20, v21
    s_add_u32 m0, s55, 2048
    v_exp_f32 v109, v109
    v_fma_f32 v108, v108, v124, v124
    v_rcp_f32 v107, v107
    buffer_load_dwordx4 v10, s[36:39], s62 offen lds
    s_add_u32 m0, s55, 3072
    v_exp_f32 v110, v110
    v_fma_f32 v109, v109, v125, v125
    v_rcp_f32 v108, v108
    v_cvt_pk_bf16_f32 v29, v106, v107
    buffer_load_dwordx4 v11, s[36:39], s62 offen lds
    v_exp_f32 v111, v111
    v_fma_f32 v110, v110, v126, v126
    v_rcp_f32 v109, v109
    v_fma_f32 v111, v111, v127, v127
    v_rcp_f32 v110, v110
    v_cvt_pk_bf16_f32 v30, v108, v109
    v_rcp_f32 v111, v111
    s_nop 0
    v_cvt_pk_bf16_f32 v31, v110, v111
    s_cmp_eq_u32 s56, 7
    s_cbranch_scc1 K_ST6
    s_waitcnt lgkmcnt(0)
    v_readfirstlane_b32 s64, v22
    v_mfma_f32_32x32x16_f16 v[96:111], v[32:35], v[248:251], 0
    ds_read_b64 v[12:13], v7 offset:512
    v_exp_f32 v64, v64
    s_mul_i32 s64, s64, s69
    s_setprio 0
    s_cmp_ge_i32 s64, 0
    s_cbranch_scc1 F12
    s_setprio 1
F12:
    v_mfma_f32_32x32x16_bf16 v[112:127], v[40:43], v[248:251], 0
    ds_read_u8 v16, v14 offset:896
    v_exp_f32 v65, v65
    v_fma_f32 v64, v64, v80, v80
    v_mfma_f32_32x32x16_bf16 v[208:223], v[24:27], v[56:59], v[208:223]
    v_exp_f32 v66, v66
    v_fma_f32 v65, v65, v81, v81
    v_rcp_f32 v64, v64
    v_mfma_f32_32x32x16_f16 v[96:111], v[36:39], v[252:255], v[96:111]
    v_exp_f32 v67, v67
    v_fma_f32 v66, v66, v82, v82
    v_rcp_f32 v65, v65
    v_mfma_f32_32x32x16_bf16 v[112:127], v[44:47], v[252:255], v[112:127]
    v_exp_f32 v68, v68
    v_fma_f32 v67, v67, v83, v83
    v_rcp_f32 v66, v66
    v_cvt_pk_bf16_f32 v24, v64, v65
    v_mfma_f32_32x32x16_bf16 v[208:223], v[28:31], v[60:63], v[208:223]
    s_waitcnt vmcnt(4)
    ds_read_b128 v[32:35], v1 offset:8192
    v_exp_f32 v69, v69
    v_fma_f32 v68, v68, v84, v84
    v_rcp_f32 v67, v67
    v_mfma_f32_32x32x16_bf16 v[96:111], v[140:143], v[244:247], v[96:111]
    ds_read_b128 v[36:39], v2 offset:8192
    v_exp_f32 v70, v70
    v_fma_f32 v69, v69, v85, v85
    v_rcp_f32 v68, v68
    v_cvt_pk_bf16_f32 v25, v66, v67
    v_smfmac_f32_32x32x32_f16 v[96:111], v[48:51], v[232:239], v52
    ds_read_b128 v[40:43], v3 offset:8192
    v_exp_f32 v71, v71
    v_fma_f32 v70, v70, v86, v86
    v_rcp_f32 v69, v69
    ds_read_b128 v[44:47], v4 offset:8192
    v_exp_f32 v72, v72
    v_fma_f32 v71, v71, v87, v87
    v_rcp_f32 v70, v70
    v_cvt_pk_bf16_f32 v26, v68, v69
    v_exp_f32 v73, v73
    v_fma_f32 v72, v72, v88, v88
    v_rcp_f32 v71, v71
    v_exp_f32 v74, v74
    v_fma_f32 v73, v73, v89, v89
    v_rcp_f32 v72, v72
    v_cvt_pk_bf16_f32 v27, v70, v71
    s_waitcnt lgkmcnt(5)
    v_mad_u32_u16 v8, v12, s60, v5
    v_mad_u32_u16 v9, v12, s60, v6 op_sel:[1,0,0,0]
    v_mad_u32_u16 v10, v13, s60, v5
    v_mad_u32_u16 v11, v13, s60, v6 op_sel:[1,0,0,0]
    s_add_u32 m0, s55, 4096
    v_exp_f32 v75, v75
    v_fma_f32 v74, v74, v90, v90
    v_rcp_f32 v73, v73
    buffer_load_dwordx4 v8, s[36:39], s61 offen lds
    ds_read_b128 v[56:59], v18 offset:0
    ds_read_b128 v[60:63], v19 offset:0
    s_add_u32 m0, s55, 5120
    v_exp_f32 v76, v76
    v_fma_f32 v75, v75, v91, v91
    v_rcp_f32 v74, v74
    v_cvt_pk_bf16_f32 v28, v72, v73
    buffer_load_dwordx4 v9, s[36:39], s61 offen lds
    s_waitcnt lgkmcnt(6)
    ds_read_b128 v[48:51], v16 offset:5232
    ds_read_u16 v52, v53 offset:896
    s_add_u32 m0, s55, 6144
    v_exp_f32 v77, v77
    v_fma_f32 v76, v76, v92, v92
    v_rcp_f32 v75, v75
    buffer_load_dwordx4 v10, s[36:39], s61 offen lds
    s_add_u32 m0, s55, 7168
    v_exp_f32 v78, v78
    v_fma_f32 v77, v77, v93, v93
    v_rcp_f32 v76, v76
    v_cvt_pk_bf16_f32 v29, v74, v75
    buffer_load_dwordx4 v11, s[36:39], s61 offen lds
    v_exp_f32 v79, v79
    v_fma_f32 v78, v78, v94, v94
    v_rcp_f32 v77, v77
    v_fma_f32 v79, v79, v95, v95
    v_rcp_f32 v78, v78
    v_cvt_pk_bf16_f32 v30, v76, v77
    v_rcp_f32 v79, v79
    s_nop 0
    v_cvt_pk_bf16_f32 v31, v78, v79
    s_waitcnt lgkmcnt(0)
    v_mfma_f32_32x32x16_f16 v[64:79], v[32:35], v[248:251], 0
    v_exp_f32 v96, v96
    v_mfma_f32_32x32x16_bf16 v[80:95], v[40:43], v[248:251], 0
    v_exp_f32 v97, v97
    v_fma_f32 v96, v96, v112, v112
    v_mfma_f32_32x32x16_bf16 v[192:207], v[24:27], v[56:59], v[192:207]
    ds_read_u16 v18, v15 offset:1792
    ds_read_u16 v19, v15 offset:1794
    v_exp_f32 v98, v98
    v_fma_f32 v97, v97, v113, v113
    v_rcp_f32 v96, v96
    v_mfma_f32_32x32x16_f16 v[64:79], v[36:39], v[252:255], v[64:79]
    v_exp_f32 v99, v99
    v_fma_f32 v98, v98, v114, v114
    v_rcp_f32 v97, v97
    v_mfma_f32_32x32x16_bf16 v[80:95], v[44:47], v[252:255], v[80:95]
    v_exp_f32 v100, v100
    v_fma_f32 v99, v99, v115, v115
    v_rcp_f32 v98, v98
    v_cvt_pk_bf16_f32 v24, v96, v97
    v_mfma_f32_32x32x16_bf16 v[192:207], v[28:31], v[60:63], v[192:207]
    s_waitcnt vmcnt(4)
    ds_read_b128 v[32:35], v1 offset:0
    v_exp_f32 v101, v101
    v_fma_f32 v100, v100, v116, v116
    v_rcp_f32 v99, v99
    v_mfma_f32_32x32x16_bf16 v[64:79], v[160:163], v[240:243], v[64:79]
    ds_read_b128 v[36:39], v2 offset:0
    v_exp_f32 v102, v102
    v_fma_f32 v101, v101, v117, v117
    v_rcp_f32 v100, v100
    v_cvt_pk_bf16_f32 v25, v98, v99
    v_smfmac_f32_32x32x32_f16 v[64:79], v[48:51], v[224:231], v52
    ds_read_b128 v[40:43], v3 offset:0
    v_exp_f32 v103, v103
    v_fma_f32 v102, v102, v118, v118
    v_rcp_f32 v101, v101
    ds_read_b128 v[44:47], v4 offset:0
    v_exp_f32 v104, v104
    v_fma_f32 v103, v103, v119, v119
    v_rcp_f32 v102, v102
    v_cvt_pk_bf16_f32 v26, v100, v101
    v_exp_f32 v105, v105
    v_fma_f32 v104, v104, v120, v120
    v_rcp_f32 v103, v103
    v_exp_f32 v106, v106
    v_fma_f32 v105, v105, v121, v121
    v_rcp_f32 v104, v104
    v_cvt_pk_bf16_f32 v27, v102, v103
    s_add_u32 m0, s55, 8192
    v_exp_f32 v107, v107
    v_fma_f32 v106, v106, v122, v122
    v_rcp_f32 v105, v105
    buffer_load_dwordx4 v8, s[36:39], s62 offen lds
    s_add_u32 m0, s55, 9216
    v_exp_f32 v108, v108
    v_fma_f32 v107, v107, v123, v123
    v_rcp_f32 v106, v106
    v_cvt_pk_bf16_f32 v28, v104, v105
    buffer_load_dwordx4 v9, s[36:39], s62 offen lds
    ds_add_rtn_u32 v22, v20, v21
    s_add_u32 m0, s55, 10240
    v_exp_f32 v109, v109
    v_fma_f32 v108, v108, v124, v124
    v_rcp_f32 v107, v107
    buffer_load_dwordx4 v10, s[36:39], s62 offen lds
    s_add_u32 m0, s55, 11264
    v_exp_f32 v110, v110
    v_fma_f32 v109, v109, v125, v125
    v_rcp_f32 v108, v108
    v_cvt_pk_bf16_f32 v29, v106, v107
    buffer_load_dwordx4 v11, s[36:39], s62 offen lds
    v_exp_f32 v111, v111
    v_fma_f32 v110, v110, v126, v126
    v_rcp_f32 v109, v109
    v_fma_f32 v111, v111, v127, v127
    v_rcp_f32 v110, v110
    v_cvt_pk_bf16_f32 v30, v108, v109
    v_rcp_f32 v111, v111
    s_nop 0
    v_cvt_pk_bf16_f32 v31, v110, v111
    s_cmp_eq_u32 s56, 8
    s_cbranch_scc1 K_ST7
    s_waitcnt lgkmcnt(0)
    v_readfirstlane_b32 s64, v22
    v_mfma_f32_32x32x16_f16 v[96:111], v[32:35], v[248:251], 0
    ds_read_b64 v[12:13], v7 offset:576
    v_exp_f32 v64, v64
    s_mul_i32 s64, s64, s69
    s_setprio 0
    s_cmp_ge_i32 s64, 0
    s_cbranch_scc1 F14
    s_setprio 1
F14:
    v_mfma_f32_32x32x16_bf16 v[112:127], v[40:43], v[248:251], 0
    ds_read_u8 v16, v14 offset:1024
    v_exp_f32 v65, v65
    v_fma_f32 v64, v64, v80, v80
    v_mfma_f32_32x32x16_bf16 v[208:223], v[24:27], v[56:59], v[208:223]
    v_exp_f32 v66, v66
    v_fma_f32 v65, v65, v81, v81
    v_rcp_f32 v64, v64
    v_mfma_f32_32x32x16_f16 v[96:111], v[36:39], v[252:255], v[96:111]
    v_exp_f32 v67, v67
    v_fma_f32 v66, v66, v82, v82
    v_rcp_f32 v65, v65
    v_mfma_f32_32x32x16_bf16 v[112:127], v[44:47], v[252:255], v[112:127]
    v_exp_f32 v68, v68
    v_fma_f32 v67, v67, v83, v83
    v_rcp_f32 v66, v66
    v_cvt_pk_bf16_f32 v24, v64, v65
    v_mfma_f32_32x32x16_bf16 v[208:223], v[28:31], v[60:63], v[208:223]
    s_waitcnt vmcnt(4)
    ds_read_b128 v[32:35], v1 offset:4096
    v_exp_f32 v69, v69
    v_fma_f32 v68, v68, v84, v84
    v_rcp_f32 v67, v67
    v_mfma_f32_32x32x16_bf16 v[96:111], v[160:163], v[244:247], v[96:111]
    ds_read_b128 v[36:39], v2 offset:4096
    v_exp_f32 v70, v70
    v_fma_f32 v69, v69, v85, v85
    v_rcp_f32 v68, v68
    v_cvt_pk_bf16_f32 v25, v66, v67
    v_smfmac_f32_32x32x32_f16 v[96:111], v[48:51], v[232:239], v52
    ds_read_b128 v[40:43], v3 offset:4096
    v_exp_f32 v71, v71
    v_fma_f32 v70, v70, v86, v86
    v_rcp_f32 v69, v69
    ds_read_b128 v[44:47], v4 offset:4096
    v_exp_f32 v72, v72
    v_fma_f32 v71, v71, v87, v87
    v_rcp_f32 v70, v70
    v_cvt_pk_bf16_f32 v26, v68, v69
    v_exp_f32 v73, v73
    v_fma_f32 v72, v72, v88, v88
    v_rcp_f32 v71, v71
    buffer_load_dwordx4 v[168:171], v168, s[28:31], 0 offen
    v_exp_f32 v74, v74
    v_fma_f32 v73, v73, v89, v89
    v_rcp_f32 v72, v72
    v_cvt_pk_bf16_f32 v27, v70, v71
    s_waitcnt lgkmcnt(5)
    v_mad_u32_u16 v8, v12, s60, v5
    v_mad_u32_u16 v9, v12, s60, v6 op_sel:[1,0,0,0]
    v_mad_u32_u16 v10, v13, s60, v5
    v_mad_u32_u16 v11, v13, s60, v6 op_sel:[1,0,0,0]
    s_add_u32 m0, s55, 0
    v_exp_f32 v75, v75
    v_fma_f32 v74, v74, v90, v90
    v_rcp_f32 v73, v73
    buffer_load_dwordx4 v8, s[36:39], s61 offen lds
    ds_read_b128 v[56:59], v18 offset:0
    ds_read_b128 v[60:63], v19 offset:0
    s_add_u32 m0, s55, 1024
    v_exp_f32 v76, v76
    v_fma_f32 v75, v75, v91, v91
    v_rcp_f32 v74, v74
    v_cvt_pk_bf16_f32 v28, v72, v73
    buffer_load_dwordx4 v9, s[36:39], s61 offen lds
    s_waitcnt lgkmcnt(6)
    ds_read_b128 v[48:51], v16 offset:5232
    ds_read_u16 v52, v53 offset:1024
    s_add_u32 m0, s55, 2048
    v_exp_f32 v77, v77
    v_fma_f32 v76, v76, v92, v92
    v_rcp_f32 v75, v75
    buffer_load_dwordx4 v10, s[36:39], s61 offen lds
    s_add_u32 m0, s55, 3072
    v_exp_f32 v78, v78
    v_fma_f32 v77, v77, v93, v93
    v_rcp_f32 v76, v76
    v_cvt_pk_bf16_f32 v29, v74, v75
    buffer_load_dwordx4 v11, s[36:39], s61 offen lds
    v_exp_f32 v79, v79
    v_fma_f32 v78, v78, v94, v94
    v_rcp_f32 v77, v77
    v_fma_f32 v79, v79, v95, v95
    v_rcp_f32 v78, v78
    v_cvt_pk_bf16_f32 v30, v76, v77
    v_rcp_f32 v79, v79
    s_nop 0
    v_cvt_pk_bf16_f32 v31, v78, v79
    s_waitcnt lgkmcnt(0)
    v_mfma_f32_32x32x16_f16 v[64:79], v[32:35], v[248:251], 0
    v_exp_f32 v96, v96
    v_mfma_f32_32x32x16_bf16 v[80:95], v[40:43], v[248:251], 0
    v_exp_f32 v97, v97
    v_fma_f32 v96, v96, v112, v112
    v_mfma_f32_32x32x16_bf16 v[192:207], v[24:27], v[56:59], v[192:207]
    ds_read_u16 v18, v15 offset:2048
    ds_read_u16 v19, v15 offset:2050
    v_exp_f32 v98, v98
    v_fma_f32 v97, v97, v113, v113
    v_rcp_f32 v96, v96
    v_mfma_f32_32x32x16_f16 v[64:79], v[36:39], v[252:255], v[64:79]
    v_exp_f32 v99, v99
    v_fma_f32 v98, v98, v114, v114
    v_rcp_f32 v97, v97
    v_mfma_f32_32x32x16_bf16 v[80:95], v[44:47], v[252:255], v[80:95]
    v_exp_f32 v100, v100
    v_fma_f32 v99, v99, v115, v115
    v_rcp_f32 v98, v98
    v_cvt_pk_bf16_f32 v24, v96, v97
    v_mfma_f32_32x32x16_bf16 v[192:207], v[28:31], v[60:63], v[192:207]
    s_waitcnt vmcnt(5)
    ds_read_b128 v[32:35], v1 offset:8192
    v_exp_f32 v101, v101
    v_fma_f32 v100, v100, v116, v116
    v_rcp_f32 v99, v99
    v_mfma_f32_32x32x16_bf16 v[64:79], v[144:147], v[240:243], v[64:79]
    ds_read_b128 v[36:39], v2 offset:8192
    v_exp_f32 v102, v102
    v_fma_f32 v101, v101, v117, v117
    v_rcp_f32 v100, v100
    v_cvt_pk_bf16_f32 v25, v98, v99
    v_smfmac_f32_32x32x32_f16 v[64:79], v[48:51], v[224:231], v52
    ds_read_b128 v[40:43], v3 offset:8192
    v_exp_f32 v103, v103
    v_fma_f32 v102, v102, v118, v118
    v_rcp_f32 v101, v101
    ds_read_b128 v[44:47], v4 offset:8192
    v_exp_f32 v104, v104
    v_fma_f32 v103, v103, v119, v119
    v_rcp_f32 v102, v102
    v_cvt_pk_bf16_f32 v26, v100, v101
    v_exp_f32 v105, v105
    v_fma_f32 v104, v104, v120, v120
    v_rcp_f32 v103, v103
    v_exp_f32 v106, v106
    v_fma_f32 v105, v105, v121, v121
    v_rcp_f32 v104, v104
    v_cvt_pk_bf16_f32 v27, v102, v103
    s_add_u32 m0, s55, 4096
    v_exp_f32 v107, v107
    v_fma_f32 v106, v106, v122, v122
    v_rcp_f32 v105, v105
    buffer_load_dwordx4 v8, s[36:39], s62 offen lds
    s_add_u32 m0, s55, 5120
    v_exp_f32 v108, v108
    v_fma_f32 v107, v107, v123, v123
    v_rcp_f32 v106, v106
    v_cvt_pk_bf16_f32 v28, v104, v105
    buffer_load_dwordx4 v9, s[36:39], s62 offen lds
    ds_add_rtn_u32 v22, v20, v21
    s_add_u32 m0, s55, 6144
    v_exp_f32 v109, v109
    v_fma_f32 v108, v108, v124, v124
    v_rcp_f32 v107, v107
    buffer_load_dwordx4 v10, s[36:39], s62 offen lds
    s_add_u32 m0, s55, 7168
    v_exp_f32 v110, v110
    v_fma_f32 v109, v109, v125, v125
    v_rcp_f32 v108, v108
    v_cvt_pk_bf16_f32 v29, v106, v107
    buffer_load_dwordx4 v11, s[36:39], s62 offen lds
    v_exp_f32 v111, v111
    v_fma_f32 v110, v110, v126, v126
    v_rcp_f32 v109, v109
    v_fma_f32 v111, v111, v127, v127
    v_rcp_f32 v110, v110
    v_cvt_pk_bf16_f32 v30, v108, v109
    v_rcp_f32 v111, v111
    s_nop 0
    v_cvt_pk_bf16_f32 v31, v110, v111
    s_cmp_eq_u32 s56, 9
    s_cbranch_scc1 K_ST8
    s_waitcnt lgkmcnt(0)
    v_readfirstlane_b32 s64, v22
    v_mfma_f32_32x32x16_f16 v[96:111], v[32:35], v[248:251], 0
    ds_read_b64 v[12:13], v7 offset:640
    v_exp_f32 v64, v64
    s_mul_i32 s64, s64, s69
    s_setprio 0
    s_cmp_ge_i32 s64, 0
    s_cbranch_scc1 F16
    s_setprio 1
F16:
    v_mfma_f32_32x32x16_bf16 v[112:127], v[40:43], v[248:251], 0
    ds_read_u8 v16, v14 offset:1152
    v_exp_f32 v65, v65
    v_fma_f32 v64, v64, v80, v80
    v_mfma_f32_32x32x16_bf16 v[208:223], v[24:27], v[56:59], v[208:223]
    v_exp_f32 v66, v66
    v_fma_f32 v65, v65, v81, v81
    v_rcp_f32 v64, v64
    v_mfma_f32_32x32x16_f16 v[96:111], v[36:39], v[252:255], v[96:111]
    v_exp_f32 v67, v67
    v_fma_f32 v66, v66, v82, v82
    v_rcp_f32 v65, v65
    v_mfma_f32_32x32x16_bf16 v[112:127], v[44:47], v[252:255], v[112:127]
    v_exp_f32 v68, v68
    v_fma_f32 v67, v67, v83, v83
    v_rcp_f32 v66, v66
    v_cvt_pk_bf16_f32 v24, v64, v65
    v_mfma_f32_32x32x16_bf16 v[208:223], v[28:31], v[60:63], v[208:223]
    s_waitcnt vmcnt(4)
    ds_read_b128 v[32:35], v1 offset:0
    v_exp_f32 v69, v69
    v_fma_f32 v68, v68, v84, v84
    v_rcp_f32 v67, v67
    v_mfma_f32_32x32x16_bf16 v[96:111], v[144:147], v[244:247], v[96:111]
    ds_read_b128 v[36:39], v2 offset:0
    v_exp_f32 v70, v70
    v_fma_f32 v69, v69, v85, v85
    v_rcp_f32 v68, v68
    v_cvt_pk_bf16_f32 v25, v66, v67
    v_smfmac_f32_32x32x32_f16 v[96:111], v[48:51], v[232:239], v52
    ds_read_b128 v[40:43], v3 offset:0
    v_exp_f32 v71, v71
    v_fma_f32 v70, v70, v86, v86
    v_rcp_f32 v69, v69
    ds_read_b128 v[44:47], v4 offset:0
    v_exp_f32 v72, v72
    v_fma_f32 v71, v71, v87, v87
    v_rcp_f32 v70, v70
    v_cvt_pk_bf16_f32 v26, v68, v69
    v_exp_f32 v73, v73
    v_fma_f32 v72, v72, v88, v88
    v_rcp_f32 v71, v71
    buffer_load_dwordx4 v[172:175], v172, s[28:31], 0 offen
    v_exp_f32 v74, v74
    v_fma_f32 v73, v73, v89, v89
    v_rcp_f32 v72, v72
    v_cvt_pk_bf16_f32 v27, v70, v71
    s_waitcnt lgkmcnt(5)
    v_mad_u32_u16 v8, v12, s60, v5
    v_mad_u32_u16 v9, v12, s60, v6 op_sel:[1,0,0,0]
    v_mad_u32_u16 v10, v13, s60, v5
    v_mad_u32_u16 v11, v13, s60, v6 op_sel:[1,0,0,0]
    s_add_u32 m0, s55, 8192
    v_exp_f32 v75, v75
    v_fma_f32 v74, v74, v90, v90
    v_rcp_f32 v73, v73
    buffer_load_dwordx4 v8, s[36:39], s61 offen lds
    ds_read_b128 v[56:59], v18 offset:0
    ds_read_b128 v[60:63], v19 offset:0
    s_add_u32 m0, s55, 9216
    v_exp_f32 v76, v76
    v_fma_f32 v75, v75, v91, v91
    v_rcp_f32 v74, v74
    v_cvt_pk_bf16_f32 v28, v72, v73
    buffer_load_dwordx4 v9, s[36:39], s61 offen lds
    s_waitcnt lgkmcnt(6)
    ds_read_b128 v[48:51], v16 offset:5232
    ds_read_u16 v52, v53 offset:1152
    s_add_u32 m0, s55, 10240
    v_exp_f32 v77, v77
    v_fma_f32 v76, v76, v92, v92
    v_rcp_f32 v75, v75
    buffer_load_dwordx4 v10, s[36:39], s61 offen lds
    s_add_u32 m0, s55, 11264
    v_exp_f32 v78, v78
    v_fma_f32 v77, v77, v93, v93
    v_rcp_f32 v76, v76
    v_cvt_pk_bf16_f32 v29, v74, v75
    buffer_load_dwordx4 v11, s[36:39], s61 offen lds
    v_exp_f32 v79, v79
    v_fma_f32 v78, v78, v94, v94
    v_rcp_f32 v77, v77
    v_fma_f32 v79, v79, v95, v95
    v_rcp_f32 v78, v78
    v_cvt_pk_bf16_f32 v30, v76, v77
    v_rcp_f32 v79, v79
    s_nop 0
    v_cvt_pk_bf16_f32 v31, v78, v79
    s_waitcnt lgkmcnt(0)
    v_mfma_f32_32x32x16_f16 v[64:79], v[32:35], v[248:251], 0
    v_exp_f32 v96, v96
    v_mfma_f32_32x32x16_bf16 v[80:95], v[40:43], v[248:251], 0
    v_exp_f32 v97, v97
    v_fma_f32 v96, v96, v112, v112
    v_mfma_f32_32x32x16_bf16 v[192:207], v[24:27], v[56:59], v[192:207]
    ds_read_u16 v18, v15 offset:2304
    ds_read_u16 v19, v15 offset:2306
    v_exp_f32 v98, v98
    v_fma_f32 v97, v97, v113, v113
    v_rcp_f32 v96, v96
    v_mfma_f32_32x32x16_f16 v[64:79], v[36:39], v[252:255], v[64:79]
    v_exp_f32 v99, v99
    v_fma_f32 v98, v98, v114, v114
    v_rcp_f32 v97, v97
    v_mfma_f32_32x32x16_bf16 v[80:95], v[44:47], v[252:255], v[80:95]
    v_exp_f32 v100, v100
    v_fma_f32 v99, v99, v115, v115
    v_rcp_f32 v98, v98
    v_cvt_pk_bf16_f32 v24, v96, v97
    v_mfma_f32_32x32x16_bf16 v[192:207], v[28:31], v[60:63], v[192:207]
    s_waitcnt vmcnt(5)
    ds_read_b128 v[32:35], v1 offset:4096
    v_exp_f32 v101, v101
    v_fma_f32 v100, v100, v116, v116
    v_rcp_f32 v99, v99
    v_mfma_f32_32x32x16_bf16 v[64:79], v[164:167], v[240:243], v[64:79]
    ds_read_b128 v[36:39], v2 offset:4096
    v_exp_f32 v102, v102
    v_fma_f32 v101, v101, v117, v117
    v_rcp_f32 v100, v100
    v_cvt_pk_bf16_f32 v25, v98, v99
    v_smfmac_f32_32x32x32_f16 v[64:79], v[48:51], v[224:231], v52
    ds_read_b128 v[40:43], v3 offset:4096
    v_exp_f32 v103, v103
    v_fma_f32 v102, v102, v118, v118
    v_rcp_f32 v101, v101
    ds_read_b128 v[44:47], v4 offset:4096
    v_exp_f32 v104, v104
    v_fma_f32 v103, v103, v119, v119
    v_rcp_f32 v102, v102
    v_cvt_pk_bf16_f32 v26, v100, v101
    v_exp_f32 v105, v105
    v_fma_f32 v104, v104, v120, v120
    v_rcp_f32 v103, v103
    v_exp_f32 v106, v106
    v_fma_f32 v105, v105, v121, v121
    v_rcp_f32 v104, v104
    v_cvt_pk_bf16_f32 v27, v102, v103
    s_add_u32 m0, s55, 0
    v_exp_f32 v107, v107
    v_fma_f32 v106, v106, v122, v122
    v_rcp_f32 v105, v105
    buffer_load_dwordx4 v8, s[36:39], s62 offen lds
    s_add_u32 m0, s55, 1024
    v_exp_f32 v108, v108
    v_fma_f32 v107, v107, v123, v123
    v_rcp_f32 v106, v106
    v_cvt_pk_bf16_f32 v28, v104, v105
    buffer_load_dwordx4 v9, s[36:39], s62 offen lds
    ds_add_rtn_u32 v22, v20, v21
    s_add_u32 m0, s55, 2048
    v_exp_f32 v109, v109
    v_fma_f32 v108, v108, v124, v124
    v_rcp_f32 v107, v107
    buffer_load_dwordx4 v10, s[36:39], s62 offen lds
    s_add_u32 m0, s55, 3072
    v_exp_f32 v110, v110
    v_fma_f32 v109, v109, v125, v125
    v_rcp_f32 v108, v108
    v_cvt_pk_bf16_f32 v29, v106, v107
    buffer_load_dwordx4 v11, s[36:39], s62 offen lds
    v_exp_f32 v111, v111
    v_fma_f32 v110, v110, v126, v126
    v_rcp_f32 v109, v109
    v_fma_f32 v111, v111, v127, v127
    v_rcp_f32 v110, v110
    v_cvt_pk_bf16_f32 v30, v108, v109
    v_rcp_f32 v111, v111
    s_nop 0
    v_cvt_pk_bf16_f32 v31, v110, v111
    s_cmp_eq_u32 s56, 10
    s_cbranch_scc1 K_ST9
    s_waitcnt lgkmcnt(0)
    v_readfirstlane_b32 s64, v22
    v_mfma_f32_32x32x16_f16 v[96:111], v[32:35], v[248:251], 0
    ds_read_b64 v[12:13], v7 offset:704
    v_exp_f32 v64, v64
    s_mul_i32 s64, s64, s69
    s_setprio 0
    s_cmp_ge_i32 s64, 0
    s_cbranch_scc1 F18
    s_setprio 1
F18:
    v_mfma_f32_32x32x16_bf16 v[112:127], v[40:43], v[248:251], 0
    ds_read_u8 v16, v14 offset:1280
    v_exp_f32 v65, v65
    v_fma_f32 v64, v64, v80, v80
    v_mfma_f32_32x32x16_bf16 v[208:223], v[24:27], v[56:59], v[208:223]
    v_exp_f32 v66, v66
    v_fma_f32 v65, v65, v81, v81
    v_rcp_f32 v64, v64
    v_mfma_f32_32x32x16_f16 v[96:111], v[36:39], v[252:255], v[96:111]
    v_exp_f32 v67, v67
    v_fma_f32 v66, v66, v82, v82
    v_rcp_f32 v65, v65
    v_mfma_f32_32x32x16_bf16 v[112:127], v[44:47], v[252:255], v[112:127]
    v_exp_f32 v68, v68
    v_fma_f32 v67, v67, v83, v83
    v_rcp_f32 v66, v66
    v_cvt_pk_bf16_f32 v24, v64, v65
    v_mfma_f32_32x32x16_bf16 v[208:223], v[28:31], v[60:63], v[208:223]
    s_waitcnt vmcnt(4)
    ds_read_b128 v[32:35], v1 offset:8192
    v_exp_f32 v69, v69
    v_fma_f32 v68, v68, v84, v84
    v_rcp_f32 v67, v67
    v_mfma_f32_32x32x16_bf16 v[96:111], v[164:167], v[244:247], v[96:111]
    ds_read_b128 v[36:39], v2 offset:8192
    v_exp_f32 v70, v70
    v_fma_f32 v69, v69, v85, v85
    v_rcp_f32 v68, v68
    v_cvt_pk_bf16_f32 v25, v66, v67
    v_smfmac_f32_32x32x32_f16 v[96:111], v[48:51], v[232:239], v52
    ds_read_b128 v[40:43], v3 offset:8192
    v_exp_f32 v71, v71
    v_fma_f32 v70, v70, v86, v86
    v_rcp_f32 v69, v69
    ds_read_b128 v[44:47], v4 offset:8192
    v_exp_f32 v72, v72
    v_fma_f32 v71, v71, v87, v87
    v_rcp_f32 v70, v70
    v_cvt_pk_bf16_f32 v26, v68, v69
    v_exp_f32 v73, v73
    v_fma_f32 v72, v72, v88, v88
    v_rcp_f32 v71, v71
    buffer_load_dwordx4 v[176:179], v176, s[28:31], 0 offen
    v_exp_f32 v74, v74
    v_fma_f32 v73, v73, v89, v89
    v_rcp_f32 v72, v72
    v_cvt_pk_bf16_f32 v27, v70, v71
    s_waitcnt lgkmcnt(5)
    v_mad_u32_u16 v8, v12, s60, v5
    v_mad_u32_u16 v9, v12, s60, v6 op_sel:[1,0,0,0]
    v_mad_u32_u16 v10, v13, s60, v5
    v_mad_u32_u16 v11, v13, s60, v6 op_sel:[1,0,0,0]
    s_add_u32 m0, s55, 4096
    v_exp_f32 v75, v75
    v_fma_f32 v74, v74, v90, v90
    v_rcp_f32 v73, v73
    buffer_load_dwordx4 v8, s[36:39], s61 offen lds
    ds_read_b128 v[56:59], v18 offset:0
    ds_read_b128 v[60:63], v19 offset:0
    s_add_u32 m0, s55, 5120
    v_exp_f32 v76, v76
    v_fma_f32 v75, v75, v91, v91
    v_rcp_f32 v74, v74
    v_cvt_pk_bf16_f32 v28, v72, v73
    buffer_load_dwordx4 v9, s[36:39], s61 offen lds
    s_waitcnt lgkmcnt(6)
    ds_read_b128 v[48:51], v16 offset:5232
    ds_read_u16 v52, v53 offset:1280
    s_add_u32 m0, s55, 6144
    v_exp_f32 v77, v77
    v_fma_f32 v76, v76, v92, v92
    v_rcp_f32 v75, v75
    buffer_load_dwordx4 v10, s[36:39], s61 offen lds
    s_add_u32 m0, s55, 7168
    v_exp_f32 v78, v78
    v_fma_f32 v77, v77, v93, v93
    v_rcp_f32 v76, v76
    v_cvt_pk_bf16_f32 v29, v74, v75
    buffer_load_dwordx4 v11, s[36:39], s61 offen lds
    v_exp_f32 v79, v79
    v_fma_f32 v78, v78, v94, v94
    v_rcp_f32 v77, v77
    v_fma_f32 v79, v79, v95, v95
    v_rcp_f32 v78, v78
    v_cvt_pk_bf16_f32 v30, v76, v77
    v_rcp_f32 v79, v79
    s_nop 0
    v_cvt_pk_bf16_f32 v31, v78, v79
    s_waitcnt lgkmcnt(0)
    v_mfma_f32_32x32x16_f16 v[64:79], v[32:35], v[248:251], 0
    v_exp_f32 v96, v96
    v_mfma_f32_32x32x16_bf16 v[80:95], v[40:43], v[248:251], 0
    v_exp_f32 v97, v97
    v_fma_f32 v96, v96, v112, v112
    v_mfma_f32_32x32x16_bf16 v[192:207], v[24:27], v[56:59], v[192:207]
    ds_read_u16 v18, v15 offset:2560
    ds_read_u16 v19, v15 offset:2562
    v_exp_f32 v98, v98
    v_fma_f32 v97, v97, v113, v113
    v_rcp_f32 v96, v96
    v_mfma_f32_32x32x16_f16 v[64:79], v[36:39], v[252:255], v[64:79]
    v_exp_f32 v99, v99
    v_fma_f32 v98, v98, v114, v114
    v_rcp_f32 v97, v97
    v_mfma_f32_32x32x16_bf16 v[80:95], v[44:47], v[252:255], v[80:95]
    v_exp_f32 v100, v100
    v_fma_f32 v99, v99, v115, v115
    v_rcp_f32 v98, v98
    v_cvt_pk_bf16_f32 v24, v96, v97
    v_mfma_f32_32x32x16_bf16 v[192:207], v[28:31], v[60:63], v[192:207]
    s_waitcnt vmcnt(5)
    ds_read_b128 v[32:35], v1 offset:0
    v_exp_f32 v101, v101
    v_fma_f32 v100, v100, v116, v116
    v_rcp_f32 v99, v99
    v_mfma_f32_32x32x16_bf16 v[64:79], v[168:171], v[240:243], v[64:79]
    ds_read_b128 v[36:39], v2 offset:0
    v_exp_f32 v102, v102
    v_fma_f32 v101, v101, v117, v117
    v_rcp_f32 v100, v100
    v_cvt_pk_bf16_f32 v25, v98, v99
    v_smfmac_f32_32x32x32_f16 v[64:79], v[48:51], v[224:231], v52
    ds_read_b128 v[40:43], v3 offset:0
    v_exp_f32 v103, v103
    v_fma_f32 v102, v102, v118, v118
    v_rcp_f32 v101, v101
    ds_read_b128 v[44:47], v4 offset:0
    v_exp_f32 v104, v104
    v_fma_f32 v103, v103, v119, v119
    v_rcp_f32 v102, v102
    v_cvt_pk_bf16_f32 v26, v100, v101
    v_exp_f32 v105, v105
    v_fma_f32 v104, v104, v120, v120
    v_rcp_f32 v103, v103
    v_exp_f32 v106, v106
    v_fma_f32 v105, v105, v121, v121
    v_rcp_f32 v104, v104
    v_cvt_pk_bf16_f32 v27, v102, v103
    s_add_u32 m0, s55, 8192
    v_exp_f32 v107, v107
    v_fma_f32 v106, v106, v122, v122
    v_rcp_f32 v105, v105
    buffer_load_dwordx4 v8, s[36:39], s62 offen lds
    s_add_u32 m0, s55, 9216
    v_exp_f32 v108, v108
    v_fma_f32 v107, v107, v123, v123
    v_rcp_f32 v106, v106
    v_cvt_pk_bf16_f32 v28, v104, v105
    buffer_load_dwordx4 v9, s[36:39], s62 offen lds
    ds_add_rtn_u32 v22, v20, v21
    s_add_u32 m0, s55, 10240
    v_exp_f32 v109, v109
    v_fma_f32 v108, v108, v124, v124
    v_rcp_f32 v107, v107
    buffer_load_dwordx4 v10, s[36:39], s62 offen lds
    s_add_u32 m0, s55, 11264
    v_exp_f32 v110, v110
    v_fma_f32 v109, v109, v125, v125
    v_rcp_f32 v108, v108
    v_cvt_pk_bf16_f32 v29, v106, v107
    buffer_load_dwordx4 v11, s[36:39], s62 offen lds
    v_exp_f32 v111, v111
    v_fma_f32 v110, v110, v126, v126
    v_rcp_f32 v109, v109
    v_fma_f32 v111, v111, v127, v127
    v_rcp_f32 v110, v110
    v_cvt_pk_bf16_f32 v30, v108, v109
    v_rcp_f32 v111, v111
    s_nop 0
    v_cvt_pk_bf16_f32 v31, v110, v111
    s_cmp_eq_u32 s56, 11
    s_cbranch_scc1 K_ST10
    s_waitcnt lgkmcnt(0)
    v_readfirstlane_b32 s64, v22
    v_mfma_f32_32x32x16_f16 v[96:111], v[32:35], v[248:251], 0
    ds_read_b64 v[12:13], v7 offset:768
    v_exp_f32 v64, v64
    s_mul_i32 s64, s64, s69
    s_setprio 0
    s_cmp_ge_i32 s64, 0
    s_cbranch_scc1 F20
    s_setprio 1
F20:
    v_mfma_f32_32x32x16_bf16 v[112:127], v[40:43], v[248:251], 0
    ds_read_u8 v16, v14 offset:1408
    v_exp_f32 v65, v65
    v_fma_f32 v64, v64, v80, v80
    v_mfma_f32_32x32x16_bf16 v[208:223], v[24:27], v[56:59], v[208:223]
    v_exp_f32 v66, v66
    v_fma_f32 v65, v65, v81, v81
    v_rcp_f32 v64, v64
    v_mfma_f32_32x32x16_f16 v[96:111], v[36:39], v[252:255], v[96:111]
    v_exp_f32 v67, v67
    v_fma_f32 v66, v66, v82, v82
    v_rcp_f32 v65, v65
    v_mfma_f32_32x32x16_bf16 v[112:127], v[44:47], v[252:255], v[112:127]
    v_exp_f32 v68, v68
    v_fma_f32 v67, v67, v83, v83
    v_rcp_f32 v66, v66
    v_cvt_pk_bf16_f32 v24, v64, v65
    v_mfma_f32_32x32x16_bf16 v[208:223], v[28:31], v[60:63], v[208:223]
    s_waitcnt vmcnt(4)
    ds_read_b128 v[32:35], v1 offset:4096
    v_exp_f32 v69, v69
    v_fma_f32 v68, v68, v84, v84
    v_rcp_f32 v67, v67
    v_mfma_f32_32x32x16_bf16 v[96:111], v[168:171], v[244:247], v[96:111]
    ds_read_b128 v[36:39], v2 offset:4096
    v_exp_f32 v70, v70
    v_fma_f32 v69, v69, v85, v85
    v_rcp_f32 v68, v68
    v_cvt_pk_bf16_f32 v25, v66, v67
    v_smfmac_f32_32x32x32_f16 v[96:111], v[48:51], v[232:239], v52
    ds_read_b128 v[40:43], v3 offset:4096
    v_exp_f32 v71, v71
    v_fma_f32 v70, v70, v86, v86
    v_rcp_f32 v69, v69
    ds_read_b128 v[44:47], v4 offset:4096
    v_exp_f32 v72, v72
    v_fma_f32 v71, v71, v87, v87
    v_rcp_f32 v70, v70
    v_cvt_pk_bf16_f32 v26, v68, v69
    v_exp_f32 v73, v73
    v_fma_f32 v72, v72, v88, v88
    v_rcp_f32 v71, v71
    buffer_load_dwordx4 v[180:183], v180, s[28:31], 0 offen
    v_exp_f32 v74, v74
    v_fma_f32 v73, v73, v89, v89
    v_rcp_f32 v72, v72
    v_cvt_pk_bf16_f32 v27, v70, v71
    s_waitcnt lgkmcnt(5)
    v_mad_u32_u16 v8, v12, s60, v5
    v_mad_u32_u16 v9, v12, s60, v6 op_sel:[1,0,0,0]
    v_mad_u32_u16 v10, v13, s60, v5
    v_mad_u32_u16 v11, v13, s60, v6 op_sel:[1,0,0,0]
    s_add_u32 m0, s55, 0
    v_exp_f32 v75, v75
    v_fma_f32 v74, v74, v90, v90
    v_rcp_f32 v73, v73
    buffer_load_dwordx4 v8, s[36:39], s61 offen lds
    ds_read_b128 v[56:59], v18 offset:0
    ds_read_b128 v[60:63], v19 offset:0
    s_add_u32 m0, s55, 1024
    v_exp_f32 v76, v76
    v_fma_f32 v75, v75, v91, v91
    v_rcp_f32 v74, v74
    v_cvt_pk_bf16_f32 v28, v72, v73
    buffer_load_dwordx4 v9, s[36:39], s61 offen lds
    s_waitcnt lgkmcnt(6)
    ds_read_b128 v[48:51], v16 offset:5232
    ds_read_u16 v52, v53 offset:1408
    s_add_u32 m0, s55, 2048
    v_exp_f32 v77, v77
    v_fma_f32 v76, v76, v92, v92
    v_rcp_f32 v75, v75
    buffer_load_dwordx4 v10, s[36:39], s61 offen lds
    s_add_u32 m0, s55, 3072
    v_exp_f32 v78, v78
    v_fma_f32 v77, v77, v93, v93
    v_rcp_f32 v76, v76
    v_cvt_pk_bf16_f32 v29, v74, v75
    buffer_load_dwordx4 v11, s[36:39], s61 offen lds
    v_exp_f32 v79, v79
    v_fma_f32 v78, v78, v94, v94
    v_rcp_f32 v77, v77
    v_fma_f32 v79, v79, v95, v95
    v_rcp_f32 v78, v78
    v_cvt_pk_bf16_f32 v30, v76, v77
    v_rcp_f32 v79, v79
    s_nop 0
    v_cvt_pk_bf16_f32 v31, v78, v79
    s_waitcnt lgkmcnt(0)
    v_mfma_f32_32x32x16_f16 v[64:79], v[32:35], v[248:251], 0
    v_exp_f32 v96, v96
    v_mfma_f32_32x32x16_bf16 v[80:95], v[40:43], v[248:251], 0
    v_exp_f32 v97, v97
    v_fma_f32 v96, v96, v112, v112
    v_mfma_f32_32x32x16_bf16 v[192:207], v[24:27], v[56:59], v[192:207]
    ds_read_u16 v18, v15 offset:2816
    ds_read_u16 v19, v15 offset:2818
    v_exp_f32 v98, v98
    v_fma_f32 v97, v97, v113, v113
    v_rcp_f32 v96, v96
    v_mfma_f32_32x32x16_f16 v[64:79], v[36:39], v[252:255], v[64:79]
    v_exp_f32 v99, v99
    v_fma_f32 v98, v98, v114, v114
    v_rcp_f32 v97, v97
    v_mfma_f32_32x32x16_bf16 v[80:95], v[44:47], v[252:255], v[80:95]
    v_exp_f32 v100, v100
    v_fma_f32 v99, v99, v115, v115
    v_rcp_f32 v98, v98
    v_cvt_pk_bf16_f32 v24, v96, v97
    v_mfma_f32_32x32x16_bf16 v[192:207], v[28:31], v[60:63], v[192:207]
    s_waitcnt vmcnt(5)
    ds_read_b128 v[32:35], v1 offset:8192
    v_exp_f32 v101, v101
    v_fma_f32 v100, v100, v116, v116
    v_rcp_f32 v99, v99
    v_mfma_f32_32x32x16_bf16 v[64:79], v[172:175], v[240:243], v[64:79]
    ds_read_b128 v[36:39], v2 offset:8192
    v_exp_f32 v102, v102
    v_fma_f32 v101, v101, v117, v117
    v_rcp_f32 v100, v100
    v_cvt_pk_bf16_f32 v25, v98, v99
    v_smfmac_f32_32x32x32_f16 v[64:79], v[48:51], v[224:231], v52
    ds_read_b128 v[40:43], v3 offset:8192
    v_exp_f32 v103, v103
    v_fma_f32 v102, v102, v118, v118
    v_rcp_f32 v101, v101
    ds_read_b128 v[44:47], v4 offset:8192
    v_exp_f32 v104, v104
    v_fma_f32 v103, v103, v119, v119
    v_rcp_f32 v102, v102
    v_cvt_pk_bf16_f32 v26, v100, v101
    v_exp_f32 v105, v105
    v_fma_f32 v104, v104, v120, v120
    v_rcp_f32 v103, v103
    v_exp_f32 v106, v106
    v_fma_f32 v105, v105, v121, v121
    v_rcp_f32 v104, v104
    v_cvt_pk_bf16_f32 v27, v102, v103
    s_add_u32 m0, s55, 4096
    v_exp_f32 v107, v107
    v_fma_f32 v106, v106, v122, v122
    v_rcp_f32 v105, v105
    buffer_load_dwordx4 v8, s[36:39], s62 offen lds
    s_add_u32 m0, s55, 5120
    v_exp_f32 v108, v108
    v_fma_f32 v107, v107, v123, v123
    v_rcp_f32 v106, v106
    v_cvt_pk_bf16_f32 v28, v104, v105
    buffer_load_dwordx4 v9, s[36:39], s62 offen lds
    ds_add_rtn_u32 v22, v20, v21
    s_add_u32 m0, s55, 6144
    v_exp_f32 v109, v109
    v_fma_f32 v108, v108, v124, v124
    v_rcp_f32 v107, v107
    buffer_load_dwordx4 v10, s[36:39], s62 offen lds
    s_add_u32 m0, s55, 7168
    v_exp_f32 v110, v110
    v_fma_f32 v109, v109, v125, v125
    v_rcp_f32 v108, v108
    v_cvt_pk_bf16_f32 v29, v106, v107
    buffer_load_dwordx4 v11, s[36:39], s62 offen lds
    v_exp_f32 v111, v111
    v_fma_f32 v110, v110, v126, v126
    v_rcp_f32 v109, v109
    v_fma_f32 v111, v111, v127, v127
    v_rcp_f32 v110, v110
    v_cvt_pk_bf16_f32 v30, v108, v109
    v_rcp_f32 v111, v111
    s_nop 0
    v_cvt_pk_bf16_f32 v31, v110, v111
    s_cmp_eq_u32 s56, 12
    s_cbranch_scc1 K_ST11
    s_waitcnt lgkmcnt(0)
    v_readfirstlane_b32 s64, v22
    v_mfma_f32_32x32x16_f16 v[96:111], v[32:35], v[248:251], 0
    ds_read_b64 v[12:13], v7 offset:832
    v_exp_f32 v64, v64
    s_mul_i32 s64, s64, s69
    s_setprio 0
    s_cmp_ge_i32 s64, 0
    s_cbranch_scc1 F22
    s_setprio 1
F22:
    v_mfma_f32_32x32x16_bf16 v[112:127], v[40:43], v[248:251], 0
    ds_read_u8 v16, v14 offset:1536
    v_exp_f32 v65, v65
    v_fma_f32 v64, v64, v80, v80
    v_mfma_f32_32x32x16_bf16 v[208:223], v[24:27], v[56:59], v[208:223]
    v_exp_f32 v66, v66
    v_fma_f32 v65, v65, v81, v81
    v_rcp_f32 v64, v64
    v_mfma_f32_32x32x16_f16 v[96:111], v[36:39], v[252:255], v[96:111]
    v_exp_f32 v67, v67
    v_fma_f32 v66, v66, v82, v82
    v_rcp_f32 v65, v65
    v_mfma_f32_32x32x16_bf16 v[112:127], v[44:47], v[252:255], v[112:127]
    v_exp_f32 v68, v68
    v_fma_f32 v67, v67, v83, v83
    v_rcp_f32 v66, v66
    v_cvt_pk_bf16_f32 v24, v64, v65
    v_mfma_f32_32x32x16_bf16 v[208:223], v[28:31], v[60:63], v[208:223]
    s_waitcnt vmcnt(4)
    ds_read_b128 v[32:35], v1 offset:0
    v_exp_f32 v69, v69
    v_fma_f32 v68, v68, v84, v84
    v_rcp_f32 v67, v67
    v_mfma_f32_32x32x16_bf16 v[96:111], v[172:175], v[244:247], v[96:111]
    ds_read_b128 v[36:39], v2 offset:0
    v_exp_f32 v70, v70
    v_fma_f32 v69, v69, v85, v85
    v_rcp_f32 v68, v68
    v_cvt_pk_bf16_f32 v25, v66, v67
    v_smfmac_f32_32x32x32_f16 v[96:111], v[48:51], v[232:239], v52
    ds_read_b128 v[40:43], v3 offset:0
    v_exp_f32 v71, v71
    v_fma_f32 v70, v70, v86, v86
    v_rcp_f32 v69, v69
    ds_read_b128 v[44:47], v4 offset:0
    v_exp_f32 v72, v72
    v_fma_f32 v71, v71, v87, v87
    v_rcp_f32 v70, v70
    v_cvt_pk_bf16_f32 v26, v68, v69
    v_exp_f32 v73, v73
    v_fma_f32 v72, v72, v88, v88
    v_rcp_f32 v71, v71
    buffer_load_dwordx4 v[184:187], v184, s[28:31], 0 offen
    v_exp_f32 v74, v74
    v_fma_f32 v73, v73, v89, v89
    v_rcp_f32 v72, v72
    v_cvt_pk_bf16_f32 v27, v70, v71
    s_waitcnt lgkmcnt(5)
    v_mad_u32_u16 v8, v12, s60, v5
    v_mad_u32_u16 v9, v12, s60, v6 op_sel:[1,0,0,0]
    v_mad_u32_u16 v10, v13, s60, v5
    v_mad_u32_u16 v11, v13, s60, v6 op_sel:[1,0,0,0]
    s_add_u32 m0, s55, 8192
    v_exp_f32 v75, v75
    v_fma_f32 v74, v74, v90, v90
    v_rcp_f32 v73, v73
    buffer_load_dwordx4 v8, s[36:39], s61 offen lds
    ds_read_b128 v[56:59], v18 offset:0
    ds_read_b128 v[60:63], v19 offset:0
    s_add_u32 m0, s55, 9216
    v_exp_f32 v76, v76
    v_fma_f32 v75, v75, v91, v91
    v_rcp_f32 v74, v74
    v_cvt_pk_bf16_f32 v28, v72, v73
    buffer_load_dwordx4 v9, s[36:39], s61 offen lds
    s_waitcnt lgkmcnt(6)
    ds_read_b128 v[48:51], v16 offset:5232
    ds_read_u16 v52, v53 offset:1536
    s_add_u32 m0, s55, 10240
    v_exp_f32 v77, v77
    v_fma_f32 v76, v76, v92, v92
    v_rcp_f32 v75, v75
    buffer_load_dwordx4 v10, s[36:39], s61 offen lds
    s_add_u32 m0, s55, 11264
    v_exp_f32 v78, v78
    v_fma_f32 v77, v77, v93, v93
    v_rcp_f32 v76, v76
    v_cvt_pk_bf16_f32 v29, v74, v75
    buffer_load_dwordx4 v11, s[36:39], s61 offen lds
    v_exp_f32 v79, v79
    v_fma_f32 v78, v78, v94, v94
    v_rcp_f32 v77, v77
    v_fma_f32 v79, v79, v95, v95
    v_rcp_f32 v78, v78
    v_cvt_pk_bf16_f32 v30, v76, v77
    v_rcp_f32 v79, v79
    s_nop 0
    v_cvt_pk_bf16_f32 v31, v78, v79
    s_waitcnt lgkmcnt(0)
    v_mfma_f32_32x32x16_f16 v[64:79], v[32:35], v[248:251], 0
    v_exp_f32 v96, v96
    v_mfma_f32_32x32x16_bf16 v[80:95], v[40:43], v[248:251], 0
    v_exp_f32 v97, v97
    v_fma_f32 v96, v96, v112, v112
    v_mfma_f32_32x32x16_bf16 v[192:207], v[24:27], v[56:59], v[192:207]
    ds_read_u16 v18, v15 offset:3072
    ds_read_u16 v19, v15 offset:3074
    v_exp_f32 v98, v98
    v_fma_f32 v97, v97, v113, v113
    v_rcp_f32 v96, v96
    v_mfma_f32_32x32x16_f16 v[64:79], v[36:39], v[252:255], v[64:79]
    v_exp_f32 v99, v99
    v_fma_f32 v98, v98, v114, v114
    v_rcp_f32 v97, v97
    v_mfma_f32_32x32x16_bf16 v[80:95], v[44:47], v[252:255], v[80:95]
    v_exp_f32 v100, v100
    v_fma_f32 v99, v99, v115, v115
    v_rcp_f32 v98, v98
    v_cvt_pk_bf16_f32 v24, v96, v97
    v_mfma_f32_32x32x16_bf16 v[192:207], v[28:31], v[60:63], v[192:207]
    s_waitcnt vmcnt(5)
    ds_read_b128 v[32:35], v1 offset:4096
    v_exp_f32 v101, v101
    v_fma_f32 v100, v100, v116, v116
    v_rcp_f32 v99, v99
    v_mfma_f32_32x32x16_bf16 v[64:79], v[176:179], v[240:243], v[64:79]
    ds_read_b128 v[36:39], v2 offset:4096
    v_exp_f32 v102, v102
    v_fma_f32 v101, v101, v117, v117
    v_rcp_f32 v100, v100
    v_cvt_pk_bf16_f32 v25, v98, v99
    v_smfmac_f32_32x32x32_f16 v[64:79], v[48:51], v[224:231], v52
    ds_read_b128 v[40:43], v3 offset:4096
    v_exp_f32 v103, v103
    v_fma_f32 v102, v102, v118, v118
    v_rcp_f32 v101, v101
    ds_read_b128 v[44:47], v4 offset:4096
    v_exp_f32 v104, v104
    v_fma_f32 v103, v103, v119, v119
    v_rcp_f32 v102, v102
    v_cvt_pk_bf16_f32 v26, v100, v101
    v_exp_f32 v105, v105
    v_fma_f32 v104, v104, v120, v120
    v_rcp_f32 v103, v103
    v_exp_f32 v106, v106
    v_fma_f32 v105, v105, v121, v121
    v_rcp_f32 v104, v104
    v_cvt_pk_bf16_f32 v27, v102, v103
    s_add_u32 m0, s55, 0
    v_exp_f32 v107, v107
    v_fma_f32 v106, v106, v122, v122
    v_rcp_f32 v105, v105
    buffer_load_dwordx4 v8, s[36:39], s62 offen lds
    s_add_u32 m0, s55, 1024
    v_exp_f32 v108, v108
    v_fma_f32 v107, v107, v123, v123
    v_rcp_f32 v106, v106
    v_cvt_pk_bf16_f32 v28, v104, v105
    buffer_load_dwordx4 v9, s[36:39], s62 offen lds
    ds_add_rtn_u32 v22, v20, v21
    s_add_u32 m0, s55, 2048
    v_exp_f32 v109, v109
    v_fma_f32 v108, v108, v124, v124
    v_rcp_f32 v107, v107
    buffer_load_dwordx4 v10, s[36:39], s62 offen lds
    s_add_u32 m0, s55, 3072
    v_exp_f32 v110, v110
    v_fma_f32 v109, v109, v125, v125
    v_rcp_f32 v108, v108
    v_cvt_pk_bf16_f32 v29, v106, v107
    buffer_load_dwordx4 v11, s[36:39], s62 offen lds
    v_exp_f32 v111, v111
    v_fma_f32 v110, v110, v126, v126
    v_rcp_f32 v109, v109
    v_fma_f32 v111, v111, v127, v127
    v_rcp_f32 v110, v110
    v_cvt_pk_bf16_f32 v30, v108, v109
    v_rcp_f32 v111, v111
    s_nop 0
    v_cvt_pk_bf16_f32 v31, v110, v111
    s_cmp_eq_u32 s56, 13
    s_cbranch_scc1 K_ST12
    s_waitcnt lgkmcnt(0)
    v_readfirstlane_b32 s64, v22
    v_mfma_f32_32x32x16_f16 v[96:111], v[32:35], v[248:251], 0
    ds_read_b64 v[12:13], v7 offset:896
    v_exp_f32 v64, v64
    s_mul_i32 s64, s64, s69
    s_setprio 0
    s_cmp_ge_i32 s64, 0
    s_cbranch_scc1 F24
    s_setprio 1
F24:
    v_mfma_f32_32x32x16_bf16 v[112:127], v[40:43], v[248:251], 0
    ds_read_u8 v16, v14 offset:1664
    v_exp_f32 v65, v65
    v_fma_f32 v64, v64, v80, v80
    v_mfma_f32_32x32x16_bf16 v[208:223], v[24:27], v[56:59], v[208:223]
    v_exp_f32 v66, v66
    v_fma_f32 v65, v65, v81, v81
    v_rcp_f32 v64, v64
    v_mfma_f32_32x32x16_f16 v[96:111], v[36:39], v[252:255], v[96:111]
    v_exp_f32 v67, v67
    v_fma_f32 v66, v66, v82, v82
    v_rcp_f32 v65, v65
    v_mfma_f32_32x32x16_bf16 v[112:127], v[44:47], v[252:255], v[112:127]
    v_exp_f32 v68, v68
    v_fma_f32 v67, v67, v83, v83
    v_rcp_f32 v66, v66
    v_cvt_pk_bf16_f32 v24, v64, v65
    v_mfma_f32_32x32x16_bf16 v[208:223], v[28:31], v[60:63], v[208:223]
    s_waitcnt vmcnt(4)
    ds_read_b128 v[32:35], v1 offset:8192
    v_exp_f32 v69, v69
    v_fma_f32 v68, v68, v84, v84
    v_rcp_f32 v67, v67
    v_mfma_f32_32x32x16_bf16 v[96:111], v[176:179], v[244:247], v[96:111]
    ds_read_b128 v[36:39], v2 offset:8192
    v_exp_f32 v70, v70
    v_fma_f32 v69, v69, v85, v85
    v_rcp_f32 v68, v68
    v_cvt_pk_bf16_f32 v25, v66, v67
    v_smfmac_f32_32x32x32_f16 v[96:111], v[48:51], v[232:239], v52
    ds_read_b128 v[40:43], v3 offset:8192
    v_exp_f32 v71, v71
    v_fma_f32 v70, v70, v86, v86
    v_rcp_f32 v69, v69
    ds_read_b128 v[44:47], v4 offset:8192
    v_exp_f32 v72, v72
    v_fma_f32 v71, v71, v87, v87
    v_rcp_f32 v70, v70
    v_cvt_pk_bf16_f32 v26, v68, v69
    v_exp_f32 v73, v73
    v_fma_f32 v72, v72, v88, v88
    v_rcp_f32 v71, v71
    buffer_load_dwordx4 v[188:191], v188, s[28:31], 0 offen
    v_exp_f32 v74, v74
    v_fma_f32 v73, v73, v89, v89
    v_rcp_f32 v72, v72
    v_cvt_pk_bf16_f32 v27, v70, v71
    s_waitcnt lgkmcnt(5)
    v_mad_u32_u16 v8, v12, s60, v5
    v_mad_u32_u16 v9, v12, s60, v6 op_sel:[1,0,0,0]
    v_mad_u32_u16 v10, v13, s60, v5
    v_mad_u32_u16 v11, v13, s60, v6 op_sel:[1,0,0,0]
    s_add_u32 m0, s55, 4096
    v_exp_f32 v75, v75
    v_fma_f32 v74, v74, v90, v90
    v_rcp_f32 v73, v73
    buffer_load_dwordx4 v8, s[36:39], s61 offen lds
    ds_read_b128 v[56:59], v18 offset:0
    ds_read_b128 v[60:63], v19 offset:0
    s_add_u32 m0, s55, 5120
    v_exp_f32 v76, v76
    v_fma_f32 v75, v75, v91, v91
    v_rcp_f32 v74, v74
    v_cvt_pk_bf16_f32 v28, v72, v73
    buffer_load_dwordx4 v9, s[36:39], s61 offen lds
    s_waitcnt lgkmcnt(6)
    ds_read_b128 v[48:51], v16 offset:5232
    ds_read_u16 v52, v53 offset:1664
    s_add_u32 m0, s55, 6144
    v_exp_f32 v77, v77
    v_fma_f32 v76, v76, v92, v92
    v_rcp_f32 v75, v75
    buffer_load_dwordx4 v10, s[36:39], s61 offen lds
    s_add_u32 m0, s55, 7168
    v_exp_f32 v78, v78
    v_fma_f32 v77, v77, v93, v93
    v_rcp_f32 v76, v76
    v_cvt_pk_bf16_f32 v29, v74, v75
    buffer_load_dwordx4 v11, s[36:39], s61 offen lds
    v_exp_f32 v79, v79
    v_fma_f32 v78, v78, v94, v94
    v_rcp_f32 v77, v77
    v_fma_f32 v79, v79, v95, v95
    v_rcp_f32 v78, v78
    v_cvt_pk_bf16_f32 v30, v76, v77
    v_rcp_f32 v79, v79
    s_nop 0
    v_cvt_pk_bf16_f32 v31, v78, v79
    s_waitcnt lgkmcnt(0)
    v_mfma_f32_32x32x16_f16 v[64:79], v[32:35], v[248:251], 0
    v_exp_f32 v96, v96
    v_mfma_f32_32x32x16_bf16 v[80:95], v[40:43], v[248:251], 0
    v_exp_f32 v97, v97
    v_fma_f32 v96, v96, v112, v112
    v_mfma_f32_32x32x16_bf16 v[192:207], v[24:27], v[56:59], v[192:207]
    ds_read_u16 v18, v15 offset:3328
    ds_read_u16 v19, v15 offset:3330
    v_exp_f32 v98, v98
    v_fma_f32 v97, v97, v113, v113
    v_rcp_f32 v96, v96
    v_mfma_f32_32x32x16_f16 v[64:79], v[36:39], v[252:255], v[64:79]
    v_exp_f32 v99, v99
    v_fma_f32 v98, v98, v114, v114
    v_rcp_f32 v97, v97
    v_mfma_f32_32x32x16_bf16 v[80:95], v[44:47], v[252:255], v[80:95]
    v_exp_f32 v100, v100
    v_fma_f32 v99, v99, v115, v115
    v_rcp_f32 v98, v98
    v_cvt_pk_bf16_f32 v24, v96, v97
    v_mfma_f32_32x32x16_bf16 v[192:207], v[28:31], v[60:63], v[192:207]
    s_waitcnt vmcnt(5)
    ds_read_b128 v[32:35], v1 offset:0
    v_exp_f32 v101, v101
    v_fma_f32 v100, v100, v116, v116
    v_rcp_f32 v99, v99
    v_mfma_f32_32x32x16_bf16 v[64:79], v[180:183], v[240:243], v[64:79]
    ds_read_b128 v[36:39], v2 offset:0
    v_exp_f32 v102, v102
    v_fma_f32 v101, v101, v117, v117
    v_rcp_f32 v100, v100
    v_cvt_pk_bf16_f32 v25, v98, v99
    v_smfmac_f32_32x32x32_f16 v[64:79], v[48:51], v[224:231], v52
    ds_read_b128 v[40:43], v3 offset:0
    v_exp_f32 v103, v103
    v_fma_f32 v102, v102, v118, v118
    v_rcp_f32 v101, v101
    ds_read_b128 v[44:47], v4 offset:0
    v_exp_f32 v104, v104
    v_fma_f32 v103, v103, v119, v119
    v_rcp_f32 v102, v102
    v_cvt_pk_bf16_f32 v26, v100, v101
    v_exp_f32 v105, v105
    v_fma_f32 v104, v104, v120, v120
    v_rcp_f32 v103, v103
    v_exp_f32 v106, v106
    v_fma_f32 v105, v105, v121, v121
    v_rcp_f32 v104, v104
    v_cvt_pk_bf16_f32 v27, v102, v103
    s_add_u32 m0, s55, 8192
    v_exp_f32 v107, v107
    v_fma_f32 v106, v106, v122, v122
    v_rcp_f32 v105, v105
    buffer_load_dwordx4 v8, s[36:39], s62 offen lds
    s_add_u32 m0, s55, 9216
    v_exp_f32 v108, v108
    v_fma_f32 v107, v107, v123, v123
    v_rcp_f32 v106, v106
    v_cvt_pk_bf16_f32 v28, v104, v105
    buffer_load_dwordx4 v9, s[36:39], s62 offen lds
    ds_add_rtn_u32 v22, v20, v21
    s_add_u32 m0, s55, 10240
    v_exp_f32 v109, v109
    v_fma_f32 v108, v108, v124, v124
    v_rcp_f32 v107, v107
    buffer_load_dwordx4 v10, s[36:39], s62 offen lds
    s_add_u32 m0, s55, 11264
    v_exp_f32 v110, v110
    v_fma_f32 v109, v109, v125, v125
    v_rcp_f32 v108, v108
    v_cvt_pk_bf16_f32 v29, v106, v107
    buffer_load_dwordx4 v11, s[36:39], s62 offen lds
    v_exp_f32 v111, v111
    v_fma_f32 v110, v110, v126, v126
    v_rcp_f32 v109, v109
    v_fma_f32 v111, v111, v127, v127
    v_rcp_f32 v110, v110
    v_cvt_pk_bf16_f32 v30, v108, v109
    v_rcp_f32 v111, v111
    s_nop 0
    v_cvt_pk_bf16_f32 v31, v110, v111
    s_cmp_eq_u32 s56, 14
    s_cbranch_scc1 K_ST13
    s_waitcnt lgkmcnt(0)
    v_readfirstlane_b32 s64, v22
    v_mfma_f32_32x32x16_f16 v[96:111], v[32:35], v[248:251], 0
    ds_read_b64 v[12:13], v7 offset:960
    v_exp_f32 v64, v64
    s_mul_i32 s64, s64, s69
    s_setprio 0
    s_cmp_ge_i32 s64, 0
    s_cbranch_scc1 F26
    s_setprio 1
F26:
    v_mfma_f32_32x32x16_bf16 v[112:127], v[40:43], v[248:251], 0
    ds_read_u8 v16, v14 offset:1792
    v_exp_f32 v65, v65
    v_fma_f32 v64, v64, v80, v80
    v_mfma_f32_32x32x16_bf16 v[208:223], v[24:27], v[56:59], v[208:223]
    v_exp_f32 v66, v66
    v_fma_f32 v65, v65, v81, v81
    v_rcp_f32 v64, v64
    v_mfma_f32_32x32x16_f16 v[96:111], v[36:39], v[252:255], v[96:111]
    v_exp_f32 v67, v67
    v_fma_f32 v66, v66, v82, v82
    v_rcp_f32 v65, v65
    v_mfma_f32_32x32x16_bf16 v[112:127], v[44:47], v[252:255], v[112:127]
    v_exp_f32 v68, v68
    v_fma_f32 v67, v67, v83, v83
    v_rcp_f32 v66, v66
    v_cvt_pk_bf16_f32 v24, v64, v65
    v_mfma_f32_32x32x16_bf16 v[208:223], v[28:31], v[60:63], v[208:223]
    s_waitcnt vmcnt(4)
    ds_read_b128 v[32:35], v1 offset:4096
    v_exp_f32 v69, v69
    v_fma_f32 v68, v68, v84, v84
    v_rcp_f32 v67, v67
    v_mfma_f32_32x32x16_bf16 v[96:111], v[180:183], v[244:247], v[96:111]
    ds_read_b128 v[36:39], v2 offset:4096
    v_exp_f32 v70, v70
    v_fma_f32 v69, v69, v85, v85
    v_rcp_f32 v68, v68
    v_cvt_pk_bf16_f32 v25, v66, v67
    v_smfmac_f32_32x32x32_f16 v[96:111], v[48:51], v[232:239], v52
    ds_read_b128 v[40:43], v3 offset:4096
    v_exp_f32 v71, v71
    v_fma_f32 v70, v70, v86, v86
    v_rcp_f32 v69, v69
    ds_read_b128 v[44:47], v4 offset:4096
    v_exp_f32 v72, v72
    v_fma_f32 v71, v71, v87, v87
    v_rcp_f32 v70, v70
    v_cvt_pk_bf16_f32 v26, v68, v69
    v_exp_f32 v73, v73
    v_fma_f32 v72, v72, v88, v88
    v_rcp_f32 v71, v71
    v_exp_f32 v74, v74
    v_fma_f32 v73, v73, v89, v89
    v_rcp_f32 v72, v72
    v_cvt_pk_bf16_f32 v27, v70, v71
    s_waitcnt lgkmcnt(5)
    v_mad_u32_u16 v8, v12, s60, v5
    v_mad_u32_u16 v9, v12, s60, v6 op_sel:[1,0,0,0]
    v_mad_u32_u16 v10, v13, s60, v5
    v_mad_u32_u16 v11, v13, s60, v6 op_sel:[1,0,0,0]
    s_add_u32 m0, s55, 0
    v_exp_f32 v75, v75
    v_fma_f32 v74, v74, v90, v90
    v_rcp_f32 v73, v73
    buffer_load_dwordx4 v8, s[36:39], s61 offen lds
    ds_read_b128 v[56:59], v18 offset:0
    ds_read_b128 v[60:63], v19 offset:0
    s_add_u32 m0, s55, 1024
    v_exp_f32 v76, v76
    v_fma_f32 v75, v75, v91, v91
    v_rcp_f32 v74, v74
    v_cvt_pk_bf16_f32 v28, v72, v73
    buffer_load_dwordx4 v9, s[36:39], s61 offen lds
    s_waitcnt lgkmcnt(6)
    ds_read_b128 v[48:51], v16 offset:5232
    ds_read_u16 v52, v53 offset:1792
    s_add_u32 m0, s55, 2048
    v_exp_f32 v77, v77
    v_fma_f32 v76, v76, v92, v92
    v_rcp_f32 v75, v75
    buffer_load_dwordx4 v10, s[36:39], s61 offen lds
    s_add_u32 m0, s55, 3072
    v_exp_f32 v78, v78
    v_fma_f32 v77, v77, v93, v93
    v_rcp_f32 v76, v76
    v_cvt_pk_bf16_f32 v29, v74, v75
    buffer_load_dwordx4 v11, s[36:39], s61 offen lds
    v_exp_f32 v79, v79
    v_fma_f32 v78, v78, v94, v94
    v_rcp_f32 v77, v77
    v_fma_f32 v79, v79, v95, v95
    v_rcp_f32 v78, v78
    v_cvt_pk_bf16_f32 v30, v76, v77
    v_rcp_f32 v79, v79
    s_nop 0
    v_cvt_pk_bf16_f32 v31, v78, v79
    s_waitcnt lgkmcnt(0)
    v_mfma_f32_32x32x16_f16 v[64:79], v[32:35], v[248:251], 0
    v_exp_f32 v96, v96
    v_mfma_f32_32x32x16_bf16 v[80:95], v[40:43], v[248:251], 0
    v_exp_f32 v97, v97
    v_fma_f32 v96, v96, v112, v112
    v_mfma_f32_32x32x16_bf16 v[192:207], v[24:27], v[56:59], v[192:207]
    ds_read_u16 v18, v15 offset:3584
    ds_read_u16 v19, v15 offset:3586
    v_exp_f32 v98, v98
    v_fma_f32 v97, v97, v113, v113
    v_rcp_f32 v96, v96
    v_mfma_f32_32x32x16_f16 v[64:79], v[36:39], v[252:255], v[64:79]
    v_exp_f32 v99, v99
    v_fma_f32 v98, v98, v114, v114
    v_rcp_f32 v97, v97
    v_mfma_f32_32x32x16_bf16 v[80:95], v[44:47], v[252:255], v[80:95]
    v_exp_f32 v100, v100
    v_fma_f32 v99, v99, v115, v115
    v_rcp_f32 v98, v98
    v_cvt_pk_bf16_f32 v24, v96, v97
    v_mfma_f32_32x32x16_bf16 v[192:207], v[28:31], v[60:63], v[192:207]
    s_waitcnt vmcnt(4)
    ds_read_b128 v[32:35], v1 offset:8192
    v_exp_f32 v101, v101
    v_fma_f32 v100, v100, v116, v116
    v_rcp_f32 v99, v99
    v_mfma_f32_32x32x16_bf16 v[64:79], v[184:187], v[240:243], v[64:79]
    ds_read_b128 v[36:39], v2 offset:8192
    v_exp_f32 v102, v102
    v_fma_f32 v101, v101, v117, v117
    v_rcp_f32 v100, v100
    v_cvt_pk_bf16_f32 v25, v98, v99
    v_smfmac_f32_32x32x32_f16 v[64:79], v[48:51], v[224:231], v52
    ds_read_b128 v[40:43], v3 offset:8192
    v_exp_f32 v103, v103
    v_fma_f32 v102, v102, v118, v118
    v_rcp_f32 v101, v101
    ds_read_b128 v[44:47], v4 offset:8192
    v_exp_f32 v104, v104
    v_fma_f32 v103, v103, v119, v119
    v_rcp_f32 v102, v102
    v_cvt_pk_bf16_f32 v26, v100, v101
    v_exp_f32 v105, v105
    v_fma_f32 v104, v104, v120, v120
    v_rcp_f32 v103, v103
    v_exp_f32 v106, v106
    v_fma_f32 v105, v105, v121, v121
    v_rcp_f32 v104, v104
    v_cvt_pk_bf16_f32 v27, v102, v103
    s_add_u32 m0, s55, 4096
    v_exp_f32 v107, v107
    v_fma_f32 v106, v106, v122, v122
    v_rcp_f32 v105, v105
    buffer_load_dwordx4 v8, s[36:39], s62 offen lds
    s_add_u32 m0, s55, 5120
    v_exp_f32 v108, v108
    v_fma_f32 v107, v107, v123, v123
    v_rcp_f32 v106, v106
    v_cvt_pk_bf16_f32 v28, v104, v105
    buffer_load_dwordx4 v9, s[36:39], s62 offen lds
    ds_add_rtn_u32 v22, v20, v21
    s_add_u32 m0, s55, 6144
    v_exp_f32 v109, v109
    v_fma_f32 v108, v108, v124, v124
    v_rcp_f32 v107, v107
    buffer_load_dwordx4 v10, s[36:39], s62 offen lds
    s_add_u32 m0, s55, 7168
    v_exp_f32 v110, v110
    v_fma_f32 v109, v109, v125, v125
    v_rcp_f32 v108, v108
    v_cvt_pk_bf16_f32 v29, v106, v107
    buffer_load_dwordx4 v11, s[36:39], s62 offen lds
    v_exp_f32 v111, v111
    v_fma_f32 v110, v110, v126, v126
    v_rcp_f32 v109, v109
    v_fma_f32 v111, v111, v127, v127
    v_rcp_f32 v110, v110
    v_cvt_pk_bf16_f32 v30, v108, v109
    v_rcp_f32 v111, v111
    s_nop 0
    v_cvt_pk_bf16_f32 v31, v110, v111
    s_cmp_eq_u32 s56, 15
    s_cbranch_scc1 K_ST14
    s_waitcnt lgkmcnt(0)
    v_readfirstlane_b32 s64, v22
    v_mfma_f32_32x32x16_f16 v[96:111], v[32:35], v[248:251], 0
    ds_read_b64 v[12:13], v7 offset:1024
    v_exp_f32 v64, v64
    s_mul_i32 s64, s64, s69
    s_setprio 0
    s_cmp_ge_i32 s64, 0
    s_cbranch_scc1 F28
    s_setprio 1
F28:
    v_mfma_f32_32x32x16_bf16 v[112:127], v[40:43], v[248:251], 0
    ds_read_u8 v16, v14 offset:1920
    v_exp_f32 v65, v65
    v_fma_f32 v64, v64, v80, v80
    v_mfma_f32_32x32x16_bf16 v[208:223], v[24:27], v[56:59], v[208:223]
    v_exp_f32 v66, v66
    v_fma_f32 v65, v65, v81, v81
    v_rcp_f32 v64, v64
    v_mfma_f32_32x32x16_f16 v[96:111], v[36:39], v[252:255], v[96:111]
    v_exp_f32 v67, v67
    v_fma_f32 v66, v66, v82, v82
    v_rcp_f32 v65, v65
    v_mfma_f32_32x32x16_bf16 v[112:127], v[44:47], v[252:255], v[112:127]
    v_exp_f32 v68, v68
    v_fma_f32 v67, v67, v83, v83
    v_rcp_f32 v66, v66
    v_cvt_pk_bf16_f32 v24, v64, v65
    v_mfma_f32_32x32x16_bf16 v[208:223], v[28:31], v[60:63], v[208:223]
    s_waitcnt vmcnt(4)
    ds_read_b128 v[32:35], v1 offset:0
    v_exp_f32 v69, v69
    v_fma_f32 v68, v68, v84, v84
    v_rcp_f32 v67, v67
    v_mfma_f32_32x32x16_bf16 v[96:111], v[184:187], v[244:247], v[96:111]
    ds_read_b128 v[36:39], v2 offset:0
    v_exp_f32 v70, v70
    v_fma_f32 v69, v69, v85, v85
    v_rcp_f32 v68, v68
    v_cvt_pk_bf16_f32 v25, v66, v67
    v_smfmac_f32_32x32x32_f16 v[96:111], v[48:51], v[232:239], v52
    ds_read_b128 v[40:43], v3 offset:0
    v_exp_f32 v71, v71
    v_fma_f32 v70, v70, v86, v86
    v_rcp_f32 v69, v69
    ds_read_b128 v[44:47], v4 offset:0
    v_exp_f32 v72, v72
    v_fma_f32 v71, v71, v87, v87
    v_rcp_f32 v70, v70
    v_cvt_pk_bf16_f32 v26, v68, v69
    v_exp_f32 v73, v73
    v_fma_f32 v72, v72, v88, v88
    v_rcp_f32 v71, v71
    v_exp_f32 v74, v74
    v_fma_f32 v73, v73, v89, v89
    v_rcp_f32 v72, v72
    v_cvt_pk_bf16_f32 v27, v70, v71
    s_waitcnt lgkmcnt(5)
    v_mad_u32_u16 v8, v12, s60, v5
    v_mad_u32_u16 v9, v12, s60, v6 op_sel:[1,0,0,0]
    v_mad_u32_u16 v10, v13, s60, v5
    v_mad_u32_u16 v11, v13, s60, v6 op_sel:[1,0,0,0]
    s_add_u32 m0, s55, 8192
    v_exp_f32 v75, v75
    v_fma_f32 v74, v74, v90, v90
    v_rcp_f32 v73, v73
    buffer_load_dwordx4 v8, s[36:39], s61 offen lds
    ds_read_b128 v[56:59], v18 offset:0
    ds_read_b128 v[60:63], v19 offset:0
    s_add_u32 m0, s55, 9216
    v_exp_f32 v76, v76
    v_fma_f32 v75, v75, v91, v91
    v_rcp_f32 v74, v74
    v_cvt_pk_bf16_f32 v28, v72, v73
    buffer_load_dwordx4 v9, s[36:39], s61 offen lds
    s_waitcnt lgkmcnt(6)
    ds_read_b128 v[48:51], v16 offset:5232
    ds_read_u16 v52, v53 offset:1920
    s_add_u32 m0, s55, 10240
    v_exp_f32 v77, v77
    v_fma_f32 v76, v76, v92, v92
    v_rcp_f32 v75, v75
    buffer_load_dwordx4 v10, s[36:39], s61 offen lds
    s_add_u32 m0, s55, 11264
    v_exp_f32 v78, v78
    v_fma_f32 v77, v77, v93, v93
    v_rcp_f32 v76, v76
    v_cvt_pk_bf16_f32 v29, v74, v75
    buffer_load_dwordx4 v11, s[36:39], s61 offen lds
    v_exp_f32 v79, v79
    v_fma_f32 v78, v78, v94, v94
    v_rcp_f32 v77, v77
    v_fma_f32 v79, v79, v95, v95
    v_rcp_f32 v78, v78
    v_cvt_pk_bf16_f32 v30, v76, v77
    v_rcp_f32 v79, v79
    s_nop 0
    v_cvt_pk_bf16_f32 v31, v78, v79
    s_waitcnt lgkmcnt(0)
    v_mfma_f32_32x32x16_f16 v[64:79], v[32:35], v[248:251], 0
    v_exp_f32 v96, v96
    v_mfma_f32_32x32x16_bf16 v[80:95], v[40:43], v[248:251], 0
    v_exp_f32 v97, v97
    v_fma_f32 v96, v96, v112, v112
    v_mfma_f32_32x32x16_bf16 v[192:207], v[24:27], v[56:59], v[192:207]
    ds_read_u16 v18, v15 offset:3840
    ds_read_u16 v19, v15 offset:3842
    v_exp_f32 v98, v98
    v_fma_f32 v97, v97, v113, v113
    v_rcp_f32 v96, v96
    v_mfma_f32_32x32x16_f16 v[64:79], v[36:39], v[252:255], v[64:79]
    v_exp_f32 v99, v99
    v_fma_f32 v98, v98, v114, v114
    v_rcp_f32 v97, v97
    v_mfma_f32_32x32x16_bf16 v[80:95], v[44:47], v[252:255], v[80:95]
    v_exp_f32 v100, v100
    v_fma_f32 v99, v99, v115, v115
    v_rcp_f32 v98, v98
    v_cvt_pk_bf16_f32 v24, v96, v97
    v_mfma_f32_32x32x16_bf16 v[192:207], v[28:31], v[60:63], v[192:207]
    s_waitcnt vmcnt(4)
    ds_read_b128 v[32:35], v1 offset:4096
    v_exp_f32 v101, v101
    v_fma_f32 v100, v100, v116, v116
    v_rcp_f32 v99, v99
    v_mfma_f32_32x32x16_bf16 v[64:79], v[188:191], v[240:243], v[64:79]
    ds_read_b128 v[36:39], v2 offset:4096
    v_exp_f32 v102, v102
    v_fma_f32 v101, v101, v117, v117
    v_rcp_f32 v100, v100
    v_cvt_pk_bf16_f32 v25, v98, v99
    v_smfmac_f32_32x32x32_f16 v[64:79], v[48:51], v[224:231], v52
    ds_read_b128 v[40:43], v3 offset:4096
    v_exp_f32 v103, v103
    v_fma_f32 v102, v102, v118, v118
    v_rcp_f32 v101, v101
    ds_read_b128 v[44:47], v4 offset:4096
    v_exp_f32 v104, v104
    v_fma_f32 v103, v103, v119, v119
    v_rcp_f32 v102, v102
    v_cvt_pk_bf16_f32 v26, v100, v101
    v_exp_f32 v105, v105
    v_fma_f32 v104, v104, v120, v120
    v_rcp_f32 v103, v103
    v_exp_f32 v106, v106
    v_fma_f32 v105, v105, v121, v121
    v_rcp_f32 v104, v104
    v_cvt_pk_bf16_f32 v27, v102, v103
    s_add_u32 m0, s55, 0
    v_exp_f32 v107, v107
    v_fma_f32 v106, v106, v122, v122
    v_rcp_f32 v105, v105
    buffer_load_dwordx4 v8, s[36:39], s62 offen lds
    s_add_u32 m0, s55, 1024
    v_exp_f32 v108, v108
    v_fma_f32 v107, v107, v123, v123
    v_rcp_f32 v106, v106
    v_cvt_pk_bf16_f32 v28, v104, v105
    buffer_load_dwordx4 v9, s[36:39], s62 offen lds
    ds_add_rtn_u32 v22, v20, v21
    s_add_u32 m0, s55, 2048
    v_exp_f32 v109, v109
    v_fma_f32 v108, v108, v124, v124
    v_rcp_f32 v107, v107
    buffer_load_dwordx4 v10, s[36:39], s62 offen lds
    s_add_u32 m0, s55, 3072
    v_exp_f32 v110, v110
    v_fma_f32 v109, v109, v125, v125
    v_rcp_f32 v108, v108
    v_cvt_pk_bf16_f32 v29, v106, v107
    buffer_load_dwordx4 v11, s[36:39], s62 offen lds
    v_exp_f32 v111, v111
    v_fma_f32 v110, v110, v126, v126
    v_rcp_f32 v109, v109
    v_fma_f32 v111, v111, v127, v127
    v_rcp_f32 v110, v110
    v_cvt_pk_bf16_f32 v30, v108, v109
    v_rcp_f32 v111, v111
    s_nop 0
    v_cvt_pk_bf16_f32 v31, v110, v111
K_ST15:
    v_mov_b32 v8, v188
    v_mov_b32 v9, v189
    v_mov_b32 v10, v190
    v_mov_b32 v11, v191
    s_branch K_LAST
K_ST14:
    v_mov_b32 v8, v184
    v_mov_b32 v9, v185
    v_mov_b32 v10, v186
    v_mov_b32 v11, v187
    s_branch K_LAST
K_ST13:
    v_mov_b32 v8, v180
    v_mov_b32 v9, v181
    v_mov_b32 v10, v182
    v_mov_b32 v11, v183
    s_branch K_LAST
K_ST12:
    v_mov_b32 v8, v176
    v_mov_b32 v9, v177
    v_mov_b32 v10, v178
    v_mov_b32 v11, v179
    s_branch K_LAST
K_ST11:
    v_mov_b32 v8, v172
    v_mov_b32 v9, v173
    v_mov_b32 v10, v174
    v_mov_b32 v11, v175
    s_branch K_LAST
K_ST10:
    v_mov_b32 v8, v168
    v_mov_b32 v9, v169
    v_mov_b32 v10, v170
    v_mov_b32 v11, v171
    s_branch K_LAST
K_ST9:
    v_mov_b32 v8, v164
    v_mov_b32 v9, v165
    v_mov_b32 v10, v166
    v_mov_b32 v11, v167
    s_branch K_LAST
K_ST8:
    v_mov_b32 v8, v144
    v_mov_b32 v9, v145
    v_mov_b32 v10, v146
    v_mov_b32 v11, v147
    s_branch K_LAST
K_ST7:
    v_mov_b32 v8, v160
    v_mov_b32 v9, v161
    v_mov_b32 v10, v162
    v_mov_b32 v11, v163
    s_branch K_LAST
K_ST6:
    v_mov_b32 v8, v140
    v_mov_b32 v9, v141
    v_mov_b32 v10, v142
    v_mov_b32 v11, v143
    s_branch K_LAST
K_ST5:
    v_mov_b32 v8, v156
    v_mov_b32 v9, v157
    v_mov_b32 v10, v158
    v_mov_b32 v11, v159
    s_branch K_LAST
K_ST4:
    v_mov_b32 v8, v136
    v_mov_b32 v9, v137
    v_mov_b32 v10, v138
    v_mov_b32 v11, v139
    s_branch K_LAST
K_ST3:
    v_mov_b32 v8, v152
    v_mov_b32 v9, v153
    v_mov_b32 v10, v154
    v_mov_b32 v11, v155
    s_branch K_LAST
K_ST2:
    v_mov_b32 v8, v132
    v_mov_b32 v9, v133
    v_mov_b32 v10, v134
    v_mov_b32 v11, v135
    s_branch K_LAST
K_ST1:
    v_mov_b32 v8, v148
    v_mov_b32 v9, v149
    v_mov_b32 v10, v150
    v_mov_b32 v11, v151
    s_branch K_LAST
K_ST0:
    v_mov_b32 v8, v128
    v_mov_b32 v9, v129
    v_mov_b32 v10, v130
    v_mov_b32 v11, v131
    s_waitcnt lgkmcnt(0)
    s_branch K_LAST0
K_LAST:
    s_waitcnt lgkmcnt(0)
    v_mfma_f32_32x32x16_bf16 v[208:223], v[24:27], v[56:59], v[208:223]
    v_mfma_f32_32x32x16_bf16 v[208:223], v[28:31], v[60:63], v[208:223]
K_LAST0:
    ds_read_b128 v[56:59], v18 offset:0
    ds_read_b128 v[60:63], v19 offset:0
    s_sub_u32 s64, s56, 1
    s_lshl_b32 s64, s64, 5
    s_sub_u32 s65, s57, s64
    v_mov_b32 v26, 0
    v_mov_b32 v27, 0
    v_mov_b32 v28, 0
    v_mov_b32 v29, 0
    v_mov_b32 v30, 0
    v_mov_b32 v31, 0
    v_exp_f32 v64, v64
    v_mfma_f32_32x32x16_f16 v[96:111], v[32:35], v[248:251], 0
    v_exp_f32 v65, v65
    v_mfma_f32_32x32x16_bf16 v[112:127], v[40:43], v[248:251], 0
    v_exp_f32 v66, v66
    v_mfma_f32_32x32x16_f16 v[96:111], v[36:39], v[252:255], v[96:111]
    v_exp_f32 v67, v67
    v_mfma_f32_32x32x16_bf16 v[112:127], v[44:47], v[252:255], v[112:127]
    v_fma_f32 v64, v64, v80, v80
    v_mfma_f32_32x32x16_bf16 v[96:111], v[8:11], v[244:247], v[96:111]
    v_fma_f32 v65, v65, v81, v81
    v_smfmac_f32_32x32x32_f16 v[96:111], v[48:51], v[232:239], v52
    v_fma_f32 v66, v66, v82, v82
    v_fma_f32 v67, v67, v83, v83
    v_rcp_f32 v64, v64
    v_rcp_f32 v65, v65
    v_rcp_f32 v66, v66
    v_rcp_f32 v67, v67
    v_cvt_pk_bf16_f32 v24, v64, v65
    v_cvt_pk_bf16_f32 v25, v66, v67
    s_cmp_le_u32 s65, 8
    s_cbranch_scc1 K_LA
    v_exp_f32 v68, v68
    v_exp_f32 v69, v69
    v_exp_f32 v70, v70
    v_exp_f32 v71, v71
    v_fma_f32 v68, v68, v84, v84
    v_fma_f32 v69, v69, v85, v85
    v_fma_f32 v70, v70, v86, v86
    v_fma_f32 v71, v71, v87, v87
    v_rcp_f32 v68, v68
    v_rcp_f32 v69, v69
    v_rcp_f32 v70, v70
    v_rcp_f32 v71, v71
    v_cvt_pk_bf16_f32 v26, v68, v69
    v_cvt_pk_bf16_f32 v27, v70, v71
    s_cmp_le_u32 s65, 16
    s_cbranch_scc1 K_LA
    v_exp_f32 v72, v72
    v_exp_f32 v73, v73
    v_exp_f32 v74, v74
    v_exp_f32 v75, v75
    v_fma_f32 v72, v72, v88, v88
    v_fma_f32 v73, v73, v89, v89
    v_fma_f32 v74, v74, v90, v90
    v_fma_f32 v75, v75, v91, v91
    v_rcp_f32 v72, v72
    v_rcp_f32 v73, v73
    v_rcp_f32 v74, v74
    v_rcp_f32 v75, v75
    v_cvt_pk_bf16_f32 v28, v72, v73
    v_cvt_pk_bf16_f32 v29, v74, v75
    s_cmp_le_u32 s65, 24
    s_cbranch_scc1 K_LA
    v_exp_f32 v76, v76
    v_exp_f32 v77, v77
    v_exp_f32 v78, v78
    v_exp_f32 v79, v79
    v_fma_f32 v76, v76, v92, v92
    v_fma_f32 v77, v77, v93, v93
    v_fma_f32 v78, v78, v94, v94
    v_fma_f32 v79, v79, v95, v95
    v_rcp_f32 v76, v76
    v_rcp_f32 v77, v77
    v_rcp_f32 v78, v78
    v_rcp_f32 v79, v79
    v_cvt_pk_bf16_f32 v30, v76, v77
    v_cvt_pk_bf16_f32 v31, v78, v79
K_LA:
    s_nop 1
    s_waitcnt lgkmcnt(0)
    v_mfma_f32_32x32x16_bf16 v[192:207], v[24:27], v[56:59], v[192:207]
    v_mfma_f32_32x32x16_bf16 v[192:207], v[28:31], v[60:63], v[192:207]
    s_nop 3
    v_mov_b32 v26, 0
    v_mov_b32 v27, 0
    v_mov_b32 v28, 0
    v_mov_b32 v29, 0
    v_mov_b32 v30, 0
    v_mov_b32 v31, 0
    v_exp_f32 v96, v96
    v_exp_f32 v97, v97
    v_exp_f32 v98, v98
    v_exp_f32 v99, v99
    v_fma_f32 v96, v96, v112, v112
    v_fma_f32 v97, v97, v113, v113
    v_fma_f32 v98, v98, v114, v114
    v_fma_f32 v99, v99, v115, v115
    v_rcp_f32 v96, v96
    v_rcp_f32 v97, v97
    v_rcp_f32 v98, v98
    v_rcp_f32 v99, v99
    v_cvt_pk_bf16_f32 v24, v96, v97
    v_cvt_pk_bf16_f32 v25, v98, v99
    s_cmp_le_u32 s65, 8
    s_cbranch_scc1 K_LB
    v_exp_f32 v100, v100
    v_exp_f32 v101, v101
    v_exp_f32 v102, v102
    v_exp_f32 v103, v103
    v_fma_f32 v100, v100, v116, v116
    v_fma_f32 v101, v101, v117, v117
    v_fma_f32 v102, v102, v118, v118
    v_fma_f32 v103, v103, v119, v119
    v_rcp_f32 v100, v100
    v_rcp_f32 v101, v101
    v_rcp_f32 v102, v102
    v_rcp_f32 v103, v103
    v_cvt_pk_bf16_f32 v26, v100, v101
    v_cvt_pk_bf16_f32 v27, v102, v103
    s_cmp_le_u32 s65, 16
    s_cbranch_scc1 K_LB
    v_exp_f32 v104, v104
    v_exp_f32 v105, v105
    v_exp_f32 v106, v106
    v_exp_f32 v107, v107
    v_fma_f32 v104, v104, v120, v120
    v_fma_f32 v105, v105, v121, v121
    v_fma_f32 v106, v106, v122, v122
    v_fma_f32 v107, v107, v123, v123
    v_rcp_f32 v104, v104
    v_rcp_f32 v105, v105
    v_rcp_f32 v106, v106
    v_rcp_f32 v107, v107
    v_cvt_pk_bf16_f32 v28, v104, v105
    v_cvt_pk_bf16_f32 v29, v106, v107
    s_cmp_le_u32 s65, 24
    s_cbranch_scc1 K_LB
    v_exp_f32 v108, v108
    v_exp_f32 v109, v109
    v_exp_f32 v110, v110
    v_exp_f32 v111, v111
    v_fma_f32 v108, v108, v124, v124
    v_fma_f32 v109, v109, v125, v125
    v_fma_f32 v110, v110, v126, v126
    v_fma_f32 v111, v111, v127, v127
    v_rcp_f32 v108, v108
    v_rcp_f32 v109, v109
    v_rcp_f32 v110, v110
    v_rcp_f32 v111, v111
    v_cvt_pk_bf16_f32 v30, v108, v109
    v_cvt_pk_bf16_f32 v31, v110, v111
K_LB:
    s_nop 1
    v_mfma_f32_32x32x16_bf16 v[208:223], v[24:27], v[56:59], v[208:223]
    v_mfma_f32_32x32x16_bf16 v[208:223], v[28:31], v[60:63], v[208:223]
K_RDONE:
    s_cmp_lg_u32 s59, 0
    s_cbranch_scc1 K_ROUND
    s_lshl_b32 s66, s54, 7
    v_mbcnt_lo_u32_b32 v20, -1, 0
    v_mbcnt_hi_u32_b32 v20, -1, v20
    v_and_b32 v21, 31, v20
    v_lshrrev_b32 v22, 5, v20
    v_lshlrev_b32 v22, 1, v22
    v_and_b32 v24, 7, v20
    v_xor_b32 v24, v24, v22
    v_lshlrev_b32 v24, 4, v24
    v_lshl_add_u32 v24, v21, 7, v24
    v_add_u32 v24, s55, v24
    v_xor_b32 v25, 16, v24
    v_xor_b32 v26, 64, v24
    v_xor_b32 v27, 80, v24
    v_lshl_add_u32 v28, v20, 4, s55
    v_lshrrev_b32 v21, 3, v20
    v_and_b32 v22, 7, v20
    v_xor_b32 v22, v22, v21
    v_add_lshl_u32 v8, v21, s67, 8
    v_lshl_add_u32 v8, v22, 4, v8
    v_add_u32 v8, s66, v8
    v_add_u32 v9, 2048, v8
    v_add_u32 v10, 4096, v8
    s_sub_u32 s64, s75, 24
    s_lshl_b32 s64, s64, 3
    v_cmp_gt_u32 vcc, s64, v20
    v_add_u32 v11, 6144, v8
    v_mov_b32 v31, 2147483392
    v_cndmask_b32 v11, v31, v11, vcc
    v_mul_f32 v64, s63, v192
    v_mul_f32 v65, s63, v193
    v_mul_f32 v66, s63, v194
    v_mul_f32 v67, s63, v195
    v_mul_f32 v68, s63, v196
    v_mul_f32 v69, s63, v197
    v_mul_f32 v70, s63, v198
    v_mul_f32 v71, s63, v199
    v_mul_f32 v72, s63, v200
    v_mul_f32 v73, s63, v201
    v_mul_f32 v74, s63, v202
    v_mul_f32 v75, s63, v203
    v_mul_f32 v76, s63, v204
    v_mul_f32 v77, s63, v205
    v_mul_f32 v78, s63, v206
    v_mul_f32 v79, s63, v207
    v_exp_f32 v64, v64
    v_exp_f32 v65, v65
    v_exp_f32 v66, v66
    v_exp_f32 v67, v67
    v_exp_f32 v68, v68
    v_exp_f32 v69, v69
    v_exp_f32 v70, v70
    v_exp_f32 v71, v71
    v_exp_f32 v72, v72
    v_exp_f32 v73, v73
    v_exp_f32 v74, v74
    v_exp_f32 v75, v75
    v_exp_f32 v76, v76
    v_exp_f32 v77, v77
    v_exp_f32 v78, v78
    v_exp_f32 v79, v79
    v_add_f32 v64, 1.0, v64
    v_add_f32 v65, 1.0, v65
    v_add_f32 v66, 1.0, v66
    v_add_f32 v67, 1.0, v67
    v_add_f32 v68, 1.0, v68
    v_add_f32 v69, 1.0, v69
    v_add_f32 v70, 1.0, v70
    v_add_f32 v71, 1.0, v71
    v_add_f32 v72, 1.0, v72
    v_add_f32 v73, 1.0, v73
    v_add_f32 v74, 1.0, v74
    v_add_f32 v75, 1.0, v75
    v_add_f32 v76, 1.0, v76
    v_add_f32 v77, 1.0, v77
    v_add_f32 v78, 1.0, v78
    v_add_f32 v79, 1.0, v79
    v_rcp_f32 v64, v64
    v_rcp_f32 v65, v65
    v_rcp_f32 v66, v66
    v_rcp_f32 v67, v67
    v_rcp_f32 v68, v68
    v_rcp_f32 v69, v69
    v_rcp_f32 v70, v70
    v_rcp_f32 v71, v71
    v_rcp_f32 v72, v72
    v_rcp_f32 v73, v73
    v_rcp_f32 v74, v74
    v_rcp_f32 v75, v75
    v_rcp_f32 v76, v76
    v_rcp_f32 v77, v77
    v_rcp_f32 v78, v78
    v_rcp_f32 v79, v79
    v_mul_f32 v64, v64, v192
    v_mul_f32 v65, v65, v193
    v_mul_f32 v66, v66, v194
    v_mul_f32 v67, v67, v195
    v_mul_f32 v68, v68, v196
    v_mul_f32 v69, v69, v197
    v_mul_f32 v70, v70, v198
    v_mul_f32 v71, v71, v199
    v_mul_f32 v72, v72, v200
    v_mul_f32 v73, v73, v201
    v_mul_f32 v74, v74, v202
    v_mul_f32 v75, v75, v203
    v_mul_f32 v76, v76, v204
    v_mul_f32 v77, v77, v205
    v_mul_f32 v78, v78, v206
    v_mul_f32 v79, v79, v207
    v_cvt_pk_bf16_f32 v96, v64, v65
    v_cvt_pk_bf16_f32 v97, v66, v67
    v_cvt_pk_bf16_f32 v98, v68, v69
    v_cvt_pk_bf16_f32 v99, v70, v71
    v_cvt_pk_bf16_f32 v100, v72, v73
    v_cvt_pk_bf16_f32 v101, v74, v75
    v_cvt_pk_bf16_f32 v102, v76, v77
    v_cvt_pk_bf16_f32 v103, v78, v79
    v_mul_f32 v80, s63, v208
    v_mul_f32 v81, s63, v209
    v_mul_f32 v82, s63, v210
    v_mul_f32 v83, s63, v211
    v_mul_f32 v84, s63, v212
    v_mul_f32 v85, s63, v213
    v_mul_f32 v86, s63, v214
    v_mul_f32 v87, s63, v215
    v_mul_f32 v88, s63, v216
    v_mul_f32 v89, s63, v217
    v_mul_f32 v90, s63, v218
    v_mul_f32 v91, s63, v219
    v_mul_f32 v92, s63, v220
    v_mul_f32 v93, s63, v221
    v_mul_f32 v94, s63, v222
    v_mul_f32 v95, s63, v223
    v_exp_f32 v80, v80
    v_exp_f32 v81, v81
    v_exp_f32 v82, v82
    v_exp_f32 v83, v83
    v_exp_f32 v84, v84
    v_exp_f32 v85, v85
    v_exp_f32 v86, v86
    v_exp_f32 v87, v87
    v_exp_f32 v88, v88
    v_exp_f32 v89, v89
    v_exp_f32 v90, v90
    v_exp_f32 v91, v91
    v_exp_f32 v92, v92
    v_exp_f32 v93, v93
    v_exp_f32 v94, v94
    v_exp_f32 v95, v95
    v_add_f32 v80, 1.0, v80
    v_add_f32 v81, 1.0, v81
    v_add_f32 v82, 1.0, v82
    v_add_f32 v83, 1.0, v83
    v_add_f32 v84, 1.0, v84
    v_add_f32 v85, 1.0, v85
    v_add_f32 v86, 1.0, v86
    v_add_f32 v87, 1.0, v87
    v_add_f32 v88, 1.0, v88
    v_add_f32 v89, 1.0, v89
    v_add_f32 v90, 1.0, v90
    v_add_f32 v91, 1.0, v91
    v_add_f32 v92, 1.0, v92
    v_add_f32 v93, 1.0, v93
    v_add_f32 v94, 1.0, v94
    v_add_f32 v95, 1.0, v95
    v_rcp_f32 v80, v80
    v_rcp_f32 v81, v81
    v_rcp_f32 v82, v82
    v_rcp_f32 v83, v83
    v_rcp_f32 v84, v84
    v_rcp_f32 v85, v85
    v_rcp_f32 v86, v86
    v_rcp_f32 v87, v87
    v_rcp_f32 v88, v88
    v_rcp_f32 v89, v89
    v_rcp_f32 v90, v90
    v_rcp_f32 v91, v91
    v_rcp_f32 v92, v92
    v_rcp_f32 v93, v93
    v_rcp_f32 v94, v94
    v_rcp_f32 v95, v95
    v_mul_f32 v80, v80, v208
    v_mul_f32 v81, v81, v209
    v_mul_f32 v82, v82, v210
    v_mul_f32 v83, v83, v211
    v_mul_f32 v84, v84, v212
    v_mul_f32 v85, v85, v213
    v_mul_f32 v86, v86, v214
    v_mul_f32 v87, v87, v215
    v_mul_f32 v88, v88, v216
    v_mul_f32 v89, v89, v217
    v_mul_f32 v90, v90, v218
    v_mul_f32 v91, v91, v219
    v_mul_f32 v92, v92, v220
    v_mul_f32 v93, v93, v221
    v_mul_f32 v94, v94, v222
    v_mul_f32 v95, v95, v223
    v_cvt_pk_bf16_f32 v104, v80, v81
    v_cvt_pk_bf16_f32 v105, v82, v83
    v_cvt_pk_bf16_f32 v106, v84, v85
    v_cvt_pk_bf16_f32 v107, v86, v87
    v_cvt_pk_bf16_f32 v108, v88, v89
    v_cvt_pk_bf16_f32 v109, v90, v91
    v_cvt_pk_bf16_f32 v110, v92, v93
    v_cvt_pk_bf16_f32 v111, v94, v95
    s_waitcnt vmcnt(0) lgkmcnt(0)
    ds_write_b128 v24, v[96:99]
    ds_write_b128 v25, v[100:103]
    ds_write_b128 v26, v[104:107]
    ds_write_b128 v27, v[108:111]
    ds_read_b128 v[64:67], v28 offset:0
    ds_read_b128 v[68:71], v28 offset:1024
    ds_read_b128 v[72:75], v28 offset:2048
    ds_read_b128 v[76:79], v28 offset:3072
    s_waitcnt lgkmcnt(3)
    buffer_store_dwordx4 v[64:67], v8, s[32:35], 0 offen sc1
    s_waitcnt lgkmcnt(2)
    buffer_store_dwordx4 v[68:71], v9, s[32:35], 0 offen sc1
    s_waitcnt lgkmcnt(1)
    buffer_store_dwordx4 v[72:75], v10, s[32:35], 0 offen sc1
    s_waitcnt lgkmcnt(0)
    buffer_store_dwordx4 v[76:79], v11, s[32:35], 0 offen sc1
    s_cmp_lg_u32 s52, 0
    s_cbranch_scc1 K_FIN
    s_cmp_eq_u32 s80, 0
    s_cbranch_scc1 K_NOWD
    s_sub_u32 s65, s79, 1
    v_mov_b32 v180, s65
    v_mov_b32 v181, s65
    v_mov_b32 v182, s65
    v_mov_b32 v183, s65
    v_mov_b32 v184, s65
    v_mov_b32 v185, s65
    v_mov_b32 v186, s65
    v_mov_b32 v187, s65
    v_mbcnt_lo_u32_b32 v20, -1, 0
    v_mbcnt_hi_u32_b32 v20, -1, v20
    s_lshl_b32 s64, s3, 11
    v_lshl_add_u32 v20, v20, 4, s64
    buffer_store_dwordx4 v[180:183], v20, s[44:47], 0 offen offset:0 sc1
    buffer_store_dwordx4 v[184:187], v20, s[44:47], 0 offen offset:1024 sc1
    v_mbcnt_lo_u32_b32 v20, -1, 0
    v_mbcnt_hi_u32_b32 v20, -1, v20
    s_lshl_b32 s64, s2, 2
    s_add_u32 s64, s64, 8192
    v_cmp_gt_u32 vcc, 8, v20
    v_lshl_add_u32 v20, v20, 10, s64
    v_mov_b32 v21, s65
    s_mov_b64 exec, vcc
    buffer_store_dword v21, v20, s[4:7], 0 offen sc1
    s_mov_b64 exec, -1
K_NOWD:
    s_cmp_lg_u32 s3, 0
    s_cbranch_scc1 K_FIN
    v_mov_b32 v20, 16384
    v_mov_b32 v21, s79
    s_mov_b64 exec, 1
    buffer_store_dword v21, v20, s[4:7], 0 offen sc1
    s_mov_b64 exec, -1
K_FIN:
K_END:
    s_endpgm
K_PLAIN:
    buffer_load_dwordx4 v[136:139], v34, s[28:31], 0 offen
    buffer_load_dwordx4 v[140:143], v35, s[28:31], 0 offen
    buffer_load_dwordx4 v[144:147], v36, s[28:31], 0 offen
    v_lshlrev_b32 v21, 3, v16
    ds_read_b32 v24, v21 offset:35648
    ds_read_b32 v25, v21 offset:39744
    ds_read_b32 v26, v21 offset:43840
    ds_read_b32 v27, v21 offset:47936
    v_and_b32 v21, 7, v16
    v_lshlrev_b32 v21, 3, v21
    v_bfe_u32 v22, v16, 3, 2
    v_lshl_add_u32 v21, v22, 1, v21
    v_lshrrev_b32 v22, 5, v16
    v_lshl_add_u32 v21, v22, 6, v21
    v_lshlrev_b32 v22, 8, v22
    v_bfe_u32 v23, v16, 2, 1
    v_lshl_add_u32 v22, v23, 7, v22
    v_bfe_u32 v23, v16, 3, 1
    v_and_b32 v12, 3, v16
    v_lshl_add_u32 v12, v23, 2, v12
    v_or_b32 v12, 0x0c0c0c00, v12
    v_mov_b32 v13, 134480385
    s_mov_b32 s64, 2840995091
    v_perm_b32 v12, s64, v13, v12
    v_and_b32 v23, 16, v16
    v_add_u32 v23, 4, v23
    v_lshlrev_b32 v12, v23, v12
    v_lshlrev_b32 v23, 2, v16
    s_waitcnt lgkmcnt(0)
    v_cmp_gt_u32 vcc, s70, v16
    s_nop 0
    s_mov_b64 exec, vcc
    s_cbranch_execz K_P0
    v_and_b32 v29, 0x7fff, v24
    ds_write_b16 v21, v29 offset:6464
    v_bfe_u32 v28, v24, 15, 5
    v_lshl_add_u32 v29, v28, 2, v22
    ds_add_u32 v29, v12 offset:19264
    v_and_b32 v29, 3, v28
    v_mul_u32_u24 v29, 0x5555, v29
    ds_write_b16 v23, v29 offset:11074
    v_lshrrev_b32 v29, 4, v28
    v_add_u32 v29, v29, v23
    v_and_b32 v24, 8, v28
    v_lshlrev_b32 v24, 2, v24
    v_and_b32 v28, 4, v28
    v_lshl_or_b32 v24, v28, 4, v24
    ds_write_b8 v29, v24 offset:11072
K_P0:
    s_mov_b64 exec, -1
    v_cmp_gt_u32 vcc, s71, v16
    s_nop 0
    s_mov_b64 exec, vcc
    s_cbranch_execz K_P1
    v_and_b32 v29, 0x7fff, v25
    ds_write_b16 v21, v29 offset:7616
    v_bfe_u32 v28, v25, 15, 5
    v_lshl_add_u32 v29, v28, 2, v22
    ds_add_u32 v29, v12 offset:23360
    v_and_b32 v29, 3, v28
    v_mul_u32_u24 v29, 0x5555, v29
    ds_write_b16 v23, v29 offset:13122
    v_lshrrev_b32 v29, 4, v28
    v_add_u32 v29, v29, v23
    v_and_b32 v25, 8, v28
    v_lshlrev_b32 v25, 2, v25
    v_and_b32 v28, 4, v28
    v_lshl_or_b32 v25, v28, 4, v25
    ds_write_b8 v29, v25 offset:13120
K_P1:
    s_mov_b64 exec, -1
    v_cmp_gt_u32 vcc, s72, v16
    s_nop 0
    s_mov_b64 exec, vcc
    s_cbranch_execz K_P2
    v_and_b32 v29, 0x7fff, v26
    ds_write_b16 v21, v29 offset:8768
    v_bfe_u32 v28, v26, 15, 5
    v_lshl_add_u32 v29, v28, 2, v22
    ds_add_u32 v29, v12 offset:27456
    v_and_b32 v29, 3, v28
    v_mul_u32_u24 v29, 0x5555, v29
    ds_write_b16 v23, v29 offset:15170
    v_lshrrev_b32 v29, 4, v28
    v_add_u32 v29, v29, v23
    v_and_b32 v26, 8, v28
    v_lshlrev_b32 v26, 2, v26
    v_and_b32 v28, 4, v28
    v_lshl_or_b32 v26, v28, 4, v26
    ds_write_b8 v29, v26 offset:15168
K_P2:
    s_mov_b64 exec, -1
    v_cmp_gt_u32 vcc, s73, v16
    s_nop 0
    s_mov_b64 exec, vcc
    s_cbranch_execz K_P3
    v_and_b32 v29, 0x7fff, v27
    ds_write_b16 v21, v29 offset:9920
    v_bfe_u32 v28, v27, 15, 5
    v_lshl_add_u32 v29, v28, 2, v22
    ds_add_u32 v29, v12 offset:31552
    v_and_b32 v29, 3, v28
    v_mul_u32_u24 v29, 0x5555, v29
    ds_write_b16 v23, v29 offset:17218
    v_lshrrev_b32 v29, 4, v28
    v_add_u32 v29, v29, v23
    v_and_b32 v27, 8, v28
    v_lshlrev_b32 v27, 2, v27
    v_and_b32 v28, 4, v28
    v_lshl_or_b32 v27, v28, 4, v27
    ds_write_b8 v29, v27 offset:17216
K_P3:
    s_mov_b64 exec, -1
    s_waitcnt lgkmcnt(0)
    s_waitcnt lgkmcnt(0)
    s_barrier
    ds_read_b64 v[12:13], v7 offset:0
    s_branch K_GO
K_OVF:
    s_cmp_eq_u32 s58, 1
    s_cselect_b32 s64, 2, 0
    s_or_b32 s81, s81, s64
    s_lshr_b32 s58, s58, 1
    s_max_u32 s58, s58, 1
    s_branch K_AGAIN
K_ROUND:
    s_mov_b32 s68, 1
    s_xor_b32 s81, s81, 1
K_AGAIN:
    s_setprio 0
    s_nop 7
    s_waitcnt vmcnt(0) lgkmcnt(0)
    s_barrier
    v_mbcnt_lo_u32_b32 v16, -1, 0
    v_mbcnt_hi_u32_b32 v16, -1, v16
    s_lshl_b32 s64, s52, 6
    v_add_u32 v16, s64, v16
    v_lshrrev_b32 v22, 16, v0
    v_min_u32 v17, s58, v22
    s_lshr_b32 s64, s81, 1
    v_xor_b32 v20, s81, v16
    v_and_b32 v20, s64, v20
    v_cmp_eq_u32 vcc, 0, v20
    s_nop 1
    v_cndmask_b32 v17, 0, v17, vcc
    v_cmp_lt_u32 vcc, v17, v22
    s_nop 0
    s_cmp_lg_u64 vcc, 0
    s_cselect_b32 s59, 1, 0
    v_and_b32 v20, 0xffff, v0
    v_lshrrev_b32 v21, 1, v16
    v_mul_u32_u24 v21, 12544, v21
    v_lshl_add_u32 v20, v20, 3, v21
    v_cmp_lt_u32 vcc, 0, v17
    s_nop 0
    s_mov_b64 exec, vcc
    s_cbranch_execz K_RL1
    buffer_load_dwordx4 v[128:131], v20, s[40:43], 0 offen offset:0
    v_cmp_lt_u32 vcc, 2, v17
    s_nop 0
    s_mov_b64 exec, vcc
    s_cbranch_execz K_RL1
    buffer_load_dwordx4 v[132:135], v20, s[40:43], 0 offen offset:16
    v_cmp_lt_u32 vcc, 4, v17
    s_nop 0
    s_mov_b64 exec, vcc
    s_cbranch_execz K_RL1
    buffer_load_dwordx4 v[136:139], v20, s[40:43], 0 offen offset:32
    v_cmp_lt_u32 vcc, 6, v17
    s_nop 0
    s_mov_b64 exec, vcc
    s_cbranch_execz K_RL1
    buffer_load_dwordx4 v[140:143], v20, s[40:43], 0 offen offset:48
    v_cmp_lt_u32 vcc, 8, v17
    s_nop 0
    s_mov_b64 exec, vcc
    s_cbranch_execz K_RL1
    buffer_load_dwordx4 v[144:147], v20, s[40:43], 0 offen offset:64
    v_cmp_lt_u32 vcc, 10, v17
    s_nop 0
    s_mov_b64 exec, vcc
    s_cbranch_execz K_RL1
    buffer_load_dwordx4 v[148:151], v20, s[40:43], 0 offen offset:80
K_RL1:
    s_mov_b64 exec, -1
    v_mov_b32 v24, 0
    v_mov_b32 v28, 0x80808080
    v_mov_b32 v25, 0
    v_mov_b32 v29, 0x80808080
    v_mov_b32 v26, 0
    v_mov_b32 v30, 0x80808080
    v_mov_b32 v27, 0
    v_mov_b32 v31, 0x80808080
    v_lshlrev_b32 v20, 4, v16
    ds_write_b128 v20, v[24:27] offset:19264
    ds_write_b128 v20, v[24:27] offset:27456
    ds_write_b128 v20, v[28:31] offset:11072
    v_cmp_gt_u32 vcc, 288, v16
    s_nop 0
    s_mov_b64 exec, vcc
    s_cbranch_execz K_I1
    ds_write_b128 v20, v[24:27] offset:6464
    v_cmp_gt_u32 vcc, 33, v16
    s_nop 0
    s_mov_b64 exec, vcc
    s_cbranch_execz K_I1
    ds_write_b128 v20, v[24:27] offset:5376
    v_cmp_gt_u32 vcc, 0, v16
    s_nop 0
    s_mov_b64 exec, vcc
    s_cbranch_execz K_I1
    ds_write_b128 v20, v[24:27] offset:35648
    v_cmp_gt_u32 vcc, 0, v16
    s_nop 0
    s_mov_b64 exec, vcc
    s_cbranch_execz K_I1
    ds_write_b128 v20, v[28:31] offset:19264
K_I1:
    s_mov_b64 exec, -1
    s_waitcnt vmcnt(0) lgkmcnt(0)
    s_barrier
    s_branch K_BUILD
K_HELP1:
    s_mov_b32 s80, 1
    s_mov_b32 s74, 0
    s_waitcnt vmcnt(0) lgkmcnt(0)
    s_barrier
    s_add_u32 s40, s18, 20971520
    s_addc_u32 s41, s19, 0
    s_and_b32 s41, s41, 0xffff
    s_mov_b32 s42, 3211264
    s_mov_b32 s43, 0x20000
    s_branch K_SORT
K_HELP1N:
    s_add_u32 s74, s74, 1
    s_cmp_lt_u32 s74, 256
    s_cbranch_scc1 K_SORT
    v_lshlrev_b32 v23, 1, v16
    v_and_b32 v23, -4, v23
    ds_read_b32 v23, v23 offset:11072
    v_mov_b32 v20, 5904
    v_mov_b32 v21, 0
    ds_write_b32 v20, v21
    s_waitcnt vmcnt(0) lgkmcnt(0)
    v_lshrrev_b32 v20, 16, v23
    v_add_u32 v21, 1, v20
    v_lshrrev_b32 v21, 1, v21
    v_sub_u32 v20, v20, v21
    v_and_b32 v0, 0xffff, v23
    v_and_b32 v22, 1, v16
    v_cmp_eq_u32 vcc, 1, v22
    v_mad_u32_u24 v0, v22, v21, v0
    s_nop 0
    v_cndmask_b32 v20, v21, v20, vcc
    v_lshl_or_b32 v0, v20, 16, v0
    s_branch K_AGAIN
K_HELP2:
    s_mov_b32 s80, 1
    s_waitcnt vmcnt(0) lgkmcnt(0)
    v_mov_b32 v17, v14
    v_mbcnt_lo_u32_b32 v21, -1, 0
    v_mbcnt_hi_u32_b32 v21, -1, v21
    v_lshrrev_b32 v20, 4, v21
    v_and_b32 v21, 15, v21
    v_lshlrev_b32 v14, 2, v20
    v_xor_b32 v14, v14, v21
    v_lshlrev_b32 v14, 4, v14
    v_lshl_add_u32 v14, v20, 8, v14
    s_lshl_b32 s64, s52, 12
    v_add_u32 v14, s64, v14
    s_mov_b32 s20, s14
    s_and_b32 s21, s15, 0xffff
    s_mov_b32 s22, 32768
    s_mov_b32 s23, 0x20000
    s_lshl_b32 s64, s52, 12
    s_mov_b32 s66, 0
    s_add_u32 m0, s64, 86016
    s_nop 0
    buffer_load_dwordx4 v14, s[20:23], s66 offen offset:0 lds
    buffer_load_dwordx4 v14, s[20:23], s66 offen offset:1024 lds
    buffer_load_dwordx4 v14, s[20:23], s66 offen offset:2048 lds
    buffer_load_dwordx4 v14, s[20:23], s66 offen offset:3072 lds
    s_mov_b32 s20, s16
    s_and_b32 s21, s17, 0xffff
    s_mov_b32 s22, 69632
    s_mov_b32 s23, 0x20000
    s_lshl_b32 s64, s52, 12
    s_mov_b32 s66, 32768
    s_add_u32 m0, s64, 53248
    s_nop 0
    buffer_load_dwordx4 v14, s[20:23], s66 offen offset:0 lds
    buffer_load_dwordx4 v14, s[20:23], s66 offen offset:1024 lds
    buffer_load_dwordx4 v14, s[20:23], s66 offen offset:2048 lds
    buffer_load_dwordx4 v14, s[20:23], s66 offen offset:3072 lds
    v_mov_b32 v14, v17
    s_mov_b32 s74, 0
K_HJOB:
    s_lshl_b32 s64, s76, 3
    s_lshr_b32 s0, 1227954432, s64
    s_and_b32 s0, s0, 0xff
    s_mul_i32 s64, s74, 98
    s_add_u32 s0, s0, s64
    v_mov_b32 v31, 2147483392
    v_mbcnt_lo_u32_b32 v21, -1, 0
    v_mbcnt_hi_u32_b32 v21, -1, v21
    v_lshrrev_b32 v20, 4, v21
    v_and_b32 v21, 15, v21
    s_lshl_b32 s64, s54, 4
    s_add_u32 s65, s64, s0
    v_add_lshl_u32 v22, v20, s65, 8
    s_sub_u32 s65, s77, s64
    s_lshl_b32 s64, s52, 12
    s_add_u32 m0, s64, 118784
    v_add_u32 v23, 0, v20
    v_xor_b32 v23, v23, v21
    v_lshl_add_u32 v23, v23, 4, v22
    buffer_load_dwordx4 v23, s[24:27], 0 offen offset:0 lds
    v_add_u32 v23, 4, v20
    v_xor_b32 v23, v23, v21
    v_lshl_add_u32 v23, v23, 4, v22
    buffer_load_dwordx4 v23, s[24:27], 0 offen offset:1024 lds
    v_add_u32 v23, 8, v20
    v_cmp_le_u32 vcc, s65, v23
    v_xor_b32 v23, v23, v21
    v_lshl_add_u32 v23, v23, 4, v22
    v_cndmask_b32 v23, v23, v31, vcc
    buffer_load_dwordx4 v23, s[24:27], 0 offen offset:2048 lds
    v_add_u32 v23, 12, v20
    v_cmp_le_u32 vcc, s65, v23
    v_xor_b32 v23, v23, v21
    v_lshl_add_u32 v23, v23, 4, v22
    v_cndmask_b32 v23, v23, v31, vcc
    buffer_load_dwordx4 v23, s[24:27], 0 offen offset:3072 lds
    s_waitcnt vmcnt(0) lgkmcnt(0)
    s_barrier
    v_mbcnt_lo_u32_b32 v20, -1, 0
    v_mbcnt_hi_u32_b32 v20, -1, v20
    v_and_b32 v21, 15, v20
    v_lshrrev_b32 v22, 5, v20
    v_xor_b32 v21, v21, v22
    v_lshlrev_b32 v21, 4, v21
    v_and_b32 v20, 31, v20
    v_lshl_add_u32 v22, v20, 8, v21
    s_lshl_b32 s64, s76, 13
    s_add_u32 s64, s64, 118784
    v_add_u32 v22, s64, v22
    v_xor_b32 v21, 0, v22
    ds_read_b128 v[96:99], v21
    v_xor_b32 v21, 32, v22
    ds_read_b128 v[100:103], v21
    v_xor_b32 v21, 64, v22
    ds_read_b128 v[104:107], v21
    v_xor_b32 v21, 96, v22
    ds_read_b128 v[108:111], v21
    v_xor_b32 v21, 128, v22
    ds_read_b128 v[112:115], v21
    v_xor_b32 v21, 160, v22
    ds_read_b128 v[116:119], v21
    v_xor_b32 v21, 192, v22
    ds_read_b128 v[120:123], v21
    v_xor_b32 v21, 224, v22
    ds_read_b128 v[124:127], v21
    s_waitcnt lgkmcnt(0)
    s_barrier
    s_lshl_b32 s66, s52, 12
    s_add_u32 s66, s66, 118784
    v_mbcnt_lo_u32_b32 v20, -1, 0
    v_mbcnt_hi_u32_b32 v20, -1, v20
    v_and_b32 v21, 31, v20
    v_lshrrev_b32 v22, 5, v20
    v_lshlrev_b32 v22, 1, v22
    v_and_b32 v24, 7, v20
    v_xor_b32 v24, v24, v22
    v_lshlrev_b32 v24, 4, v24
    v_lshl_add_u32 v24, v21, 7, v24
    v_add_u32 v24, s66, v24
    v_xor_b32 v25, 16, v24
    v_xor_b32 v26, 64, v24
    v_xor_b32 v27, 80, v24
    v_lshl_add_u32 v28, v20, 4, s66
    v_lshrrev_b32 v21, 3, v20
    v_and_b32 v22, 7, v20
    v_xor_b32 v22, v22, v21
    v_add_lshl_u32 v8, v21, s0, 9
    v_lshl_add_u32 v8, v22, 4, v8
    v_add_u32 v8, s61, v8
    v_add_u32 v9, 4096, v8
    v_add_u32 v10, 8192, v8
    s_sub_u32 s64, s77, 24
    s_lshl_b32 s64, s64, 3
    v_cmp_gt_u32 vcc, s64, v20
    v_add_u32 v11, 12288, v8
    v_mov_b32 v31, 2147483392
    v_cndmask_b32 v11, v31, v11, vcc
    v_mov_b32 v29, 0xff7f0000
    ds_read_b64_tr_b16 v[48:49], v18 offset:0
    ds_read_b64_tr_b16 v[50:51], v18 offset:1024
    ds_read_b64_tr_b16 v[52:53], v18 offset:32768
    ds_read_b64_tr_b16 v[54:55], v18 offset:33792
    ds_read_b64_tr_b16 v[56:57], v18 offset:4096
    ds_read_b64_tr_b16 v[58:59], v18 offset:5120
    ds_read_b64_tr_b16 v[60:61], v18 offset:36864
    ds_read_b64_tr_b16 v[62:63], v18 offset:37888
    s_waitcnt lgkmcnt(4)
    v_mfma_f32_32x32x16_bf16 v[64:79], v[48:51], v[96:99], 0
    v_mfma_f32_32x32x16_bf16 v[80:95], v[52:55], v[96:99], 0
    ds_read_b64_tr_b16 v[48:49], v18 offset:8192
    ds_read_b64_tr_b16 v[50:51], v18 offset:9216
    ds_read_b64_tr_b16 v[52:53], v18 offset:40960
    ds_read_b64_tr_b16 v[54:55], v18 offset:41984
    s_waitcnt lgkmcnt(4)
    v_mfma_f32_32x32x16_bf16 v[64:79], v[56:59], v[100:103], v[64:79]
    v_mfma_f32_32x32x16_bf16 v[80:95], v[60:63], v[100:103], v[80:95]
    ds_read_b64_tr_b16 v[56:57], v18 offset:12288
    ds_read_b64_tr_b16 v[58:59], v18 offset:13312
    ds_read_b64_tr_b16 v[60:61], v18 offset:45056
    ds_read_b64_tr_b16 v[62:63], v18 offset:46080
    s_waitcnt lgkmcnt(4)
    v_mfma_f32_32x32x16_bf16 v[64:79], v[48:51], v[104:107], v[64:79]
    v_mfma_f32_32x32x16_bf16 v[80:95], v[52:55], v[104:107], v[80:95]
    ds_read_b64_tr_b16 v[48:49], v18 offset:16384
    ds_read_b64_tr_b16 v[50:51], v18 offset:17408
    ds_read_b64_tr_b16 v[52:53], v18 offset:49152
    ds_read_b64_tr_b16 v[54:55], v18 offset:50176
    s_waitcnt lgkmcnt(4)
    v_mfma_f32_32x32x16_bf16 v[64:79], v[56:59], v[108:111], v[64:79]
    v_mfma_f32_32x32x16_bf16 v[80:95], v[60:63], v[108:111], v[80:95]
    ds_read_b64_tr_b16 v[56:57], v18 offset:20480
    ds_read_b64_tr_b16 v[58:59], v18 offset:21504
    ds_read_b64_tr_b16 v[60:61], v18 offset:53248
    ds_read_b64_tr_b16 v[62:63], v18 offset:54272
    s_waitcnt lgkmcnt(4)
    v_mfma_f32_32x32x16_bf16 v[64:79], v[48:51], v[112:115], v[64:79]
    v_mfma_f32_32x32x16_bf16 v[80:95], v[52:55], v[112:115], v[80:95]
    ds_read_b64_tr_b16 v[48:49], v18 offset:24576
    ds_read_b64_tr_b16 v[50:51], v18 offset:25600
    ds_read_b64_tr_b16 v[52:53], v18 offset:57344
    ds_read_b64_tr_b16 v[54:55], v18 offset:58368
    s_waitcnt lgkmcnt(4)
    v_mfma_f32_32x32x16_bf16 v[64:79], v[56:59], v[116:119], v[64:79]
    v_mfma_f32_32x32x16_bf16 v[80:95], v[60:63], v[116:119], v[80:95]
    ds_read_b64_tr_b16 v[56:57], v18 offset:28672
    ds_read_b64_tr_b16 v[58:59], v18 offset:29696
    ds_read_b64_tr_b16 v[60:61], v18 offset:61440
    ds_read_b64_tr_b16 v[62:63], v18 offset:62464
    s_waitcnt lgkmcnt(4)
    v_mfma_f32_32x32x16_bf16 v[64:79], v[48:51], v[120:123], v[64:79]
    v_mfma_f32_32x32x16_bf16 v[80:95], v[52:55], v[120:123], v[80:95]
    s_waitcnt lgkmcnt(0)
    v_mfma_f32_32x32x16_bf16 v[64:79], v[56:59], v[124:127], v[64:79]
    v_mfma_f32_32x32x16_bf16 v[80:95], v[60:63], v[124:127], v[80:95]
    s_mov_b32 s65, 0x7f7f0000
    s_nop 9
    v_mul_f32 v64, s63, v64
    v_mul_f32 v65, s63, v65
    v_mul_f32 v66, s63, v66
    v_mul_f32 v67, s63, v67
    v_mul_f32 v68, s63, v68
    v_mul_f32 v69, s63, v69
    v_mul_f32 v70, s63, v70
    v_mul_f32 v71, s63, v71
    v_mul_f32 v72, s63, v72
    v_mul_f32 v73, s63, v73
    v_mul_f32 v74, s63, v74
    v_mul_f32 v75, s63, v75
    v_mul_f32 v76, s63, v76
    v_mul_f32 v77, s63, v77
    v_mul_f32 v78, s63, v78
    v_mul_f32 v79, s63, v79
    v_rcp_f32 v80, v80
    v_rcp_f32 v81, v81
    v_rcp_f32 v82, v82
    v_rcp_f32 v83, v83
    v_rcp_f32 v84, v84
    v_rcp_f32 v85, v85
    v_rcp_f32 v86, v86
    v_rcp_f32 v87, v87
    v_rcp_f32 v88, v88
    v_rcp_f32 v89, v89
    v_rcp_f32 v90, v90
    v_rcp_f32 v91, v91
    v_rcp_f32 v92, v92
    v_rcp_f32 v93, v93
    v_rcp_f32 v94, v94
    v_rcp_f32 v95, v95
    v_cvt_pk_f16_f32 v32, v64, v65
    v_cvt_pk_f16_f32 v33, v66, v67
    v_cvt_pk_f16_f32 v34, v68, v69
    v_cvt_pk_f16_f32 v35, v70, v71
    v_cvt_pk_f16_f32 v36, v72, v73
    v_cvt_pk_f16_f32 v37, v74, v75
    v_cvt_pk_f16_f32 v38, v76, v77
    v_cvt_pk_f16_f32 v39, v78, v79
    v_med3_f32 v80, v80, v29, s65
    v_med3_f32 v81, v81, v29, s65
    v_med3_f32 v82, v82, v29, s65
    v_med3_f32 v83, v83, v29, s65
    v_med3_f32 v84, v84, v29, s65
    v_med3_f32 v85, v85, v29, s65
    v_med3_f32 v86, v86, v29, s65
    v_med3_f32 v87, v87, v29, s65
    v_med3_f32 v88, v88, v29, s65
    v_med3_f32 v89, v89, v29, s65
    v_med3_f32 v90, v90, v29, s65
    v_med3_f32 v91, v91, v29, s65
    v_med3_f32 v92, v92, v29, s65
    v_med3_f32 v93, v93, v29, s65
    v_med3_f32 v94, v94, v29, s65
    v_med3_f32 v95, v95, v29, s65
    v_cvt_pk_bf16_f32 v40, v80, v81
    v_cvt_pk_bf16_f32 v41, v82, v83
    v_cvt_pk_bf16_f32 v42, v84, v85
    v_cvt_pk_bf16_f32 v43, v86, v87
    v_cvt_pk_bf16_f32 v44, v88, v89
    v_cvt_pk_bf16_f32 v45, v90, v91
    v_cvt_pk_bf16_f32 v46, v92, v93
    v_cvt_pk_bf16_f32 v47, v94, v95
    ds_write_b128 v24, v[32:35]
    ds_write_b128 v25, v[36:39]
    ds_write_b128 v26, v[40:43]
    ds_write_b128 v27, v[44:47]
    ds_read_b128 v[64:67], v28 offset:0
    ds_read_b128 v[68:71], v28 offset:1024
    ds_read_b128 v[72:75], v28 offset:2048
    ds_read_b128 v[76:79], v28 offset:3072
    s_waitcnt lgkmcnt(3)
    buffer_store_dwordx4 v[64:67], v8, s[36:39], 0 offen offset:0 sc1
    s_waitcnt lgkmcnt(2)
    buffer_store_dwordx4 v[68:71], v9, s[36:39], 0 offen offset:0 sc1
    s_waitcnt lgkmcnt(1)
    buffer_store_dwordx4 v[72:75], v10, s[36:39], 0 offen offset:0 sc1
    s_waitcnt lgkmcnt(0)
    buffer_store_dwordx4 v[76:79], v11, s[36:39], 0 offen offset:0 sc1
    ds_read_b64_tr_b16 v[48:49], v19 offset:0
    ds_read_b64_tr_b16 v[50:51], v19 offset:1024
    ds_read_b64_tr_b16 v[52:53], v19 offset:32768
    ds_read_b64_tr_b16 v[54:55], v19 offset:33792
    ds_read_b64_tr_b16 v[56:57], v19 offset:4096
    ds_read_b64_tr_b16 v[58:59], v19 offset:5120
    ds_read_b64_tr_b16 v[60:61], v19 offset:36864
    ds_read_b64_tr_b16 v[62:63], v19 offset:37888
    s_waitcnt lgkmcnt(4)
    v_mfma_f32_32x32x16_bf16 v[64:79], v[48:51], v[96:99], 0
    v_mfma_f32_32x32x16_bf16 v[80:95], v[52:55], v[96:99], 0
    ds_read_b64_tr_b16 v[48:49], v19 offset:8192
    ds_read_b64_tr_b16 v[50:51], v19 offset:9216
    ds_read_b64_tr_b16 v[52:53], v19 offset:40960
    ds_read_b64_tr_b16 v[54:55], v19 offset:41984
    s_waitcnt lgkmcnt(4)
    v_mfma_f32_32x32x16_bf16 v[64:79], v[56:59], v[100:103], v[64:79]
    v_mfma_f32_32x32x16_bf16 v[80:95], v[60:63], v[100:103], v[80:95]
    ds_read_b64_tr_b16 v[56:57], v19 offset:12288
    ds_read_b64_tr_b16 v[58:59], v19 offset:13312
    ds_read_b64_tr_b16 v[60:61], v19 offset:45056
    ds_read_b64_tr_b16 v[62:63], v19 offset:46080
    s_waitcnt lgkmcnt(4)
    v_mfma_f32_32x32x16_bf16 v[64:79], v[48:51], v[104:107], v[64:79]
    v_mfma_f32_32x32x16_bf16 v[80:95], v[52:55], v[104:107], v[80:95]
    ds_read_b64_tr_b16 v[48:49], v19 offset:16384
    ds_read_b64_tr_b16 v[50:51], v19 offset:17408
    ds_read_b64_tr_b16 v[52:53], v19 offset:49152
    ds_read_b64_tr_b16 v[54:55], v19 offset:50176
    s_waitcnt lgkmcnt(4)
    v_mfma_f32_32x32x16_bf16 v[64:79], v[56:59], v[108:111], v[64:79]
    v_mfma_f32_32x32x16_bf16 v[80:95], v[60:63], v[108:111], v[80:95]
    ds_read_b64_tr_b16 v[56:57], v19 offset:20480
    ds_read_b64_tr_b16 v[58:59], v19 offset:21504
    ds_read_b64_tr_b16 v[60:61], v19 offset:53248
    ds_read_b64_tr_b16 v[62:63], v19 offset:54272
    s_waitcnt lgkmcnt(4)
    v_mfma_f32_32x32x16_bf16 v[64:79], v[48:51], v[112:115], v[64:79]
    v_mfma_f32_32x32x16_bf16 v[80:95], v[52:55], v[112:115], v[80:95]
    ds_read_b64_tr_b16 v[48:49], v19 offset:24576
    ds_read_b64_tr_b16 v[50:51], v19 offset:25600
    ds_read_b64_tr_b16 v[52:53], v19 offset:57344
    ds_read_b64_tr_b16 v[54:55], v19 offset:58368
    s_waitcnt lgkmcnt(4)
    v_mfma_f32_32x32x16_bf16 v[64:79], v[56:59], v[116:119], v[64:79]
    v_mfma_f32_32x32x16_bf16 v[80:95], v[60:63], v[116:119], v[80:95]
    ds_read_b64_tr_b16 v[56:57], v19 offset:28672
    ds_read_b64_tr_b16 v[58:59], v19 offset:29696
    ds_read_b64_tr_b16 v[60:61], v19 offset:61440
    ds_read_b64_tr_b16 v[62:63], v19 offset:62464
    s_waitcnt lgkmcnt(4)
    v_mfma_f32_32x32x16_bf16 v[64:79], v[48:51], v[120:123], v[64:79]
    v_mfma_f32_32x32x16_bf16 v[80:95], v[52:55], v[120:123], v[80:95]
    s_waitcnt lgkmcnt(0)
    v_mfma_f32_32x32x16_bf16 v[64:79], v[56:59], v[124:127], v[64:79]
    v_mfma_f32_32x32x16_bf16 v[80:95], v[60:63], v[124:127], v[80:95]
    s_mov_b32 s65, 0x7f7f0000
    s_nop 9
    v_mul_f32 v64, s63, v64
    v_mul_f32 v65, s63, v65
    v_mul_f32 v66, s63, v66
    v_mul_f32 v67, s63, v67
    v_mul_f32 v68, s63, v68
    v_mul_f32 v69, s63, v69
    v_mul_f32 v70, s63, v70
    v_mul_f32 v71, s63, v71
    v_mul_f32 v72, s63, v72
    v_mul_f32 v73, s63, v73
    v_mul_f32 v74, s63, v74
    v_mul_f32 v75, s63, v75
    v_mul_f32 v76, s63, v76
    v_mul_f32 v77, s63, v77
    v_mul_f32 v78, s63, v78
    v_mul_f32 v79, s63, v79
    v_rcp_f32 v80, v80
    v_rcp_f32 v81, v81
    v_rcp_f32 v82, v82
    v_rcp_f32 v83, v83
    v_rcp_f32 v84, v84
    v_rcp_f32 v85, v85
    v_rcp_f32 v86, v86
    v_rcp_f32 v87, v87
    v_rcp_f32 v88, v88
    v_rcp_f32 v89, v89
    v_rcp_f32 v90, v90
    v_rcp_f32 v91, v91
    v_rcp_f32 v92, v92
    v_rcp_f32 v93, v93
    v_rcp_f32 v94, v94
    v_rcp_f32 v95, v95
    v_cvt_pk_f16_f32 v32, v64, v65
    v_cvt_pk_f16_f32 v33, v66, v67
    v_cvt_pk_f16_f32 v34, v68, v69
    v_cvt_pk_f16_f32 v35, v70, v71
    v_cvt_pk_f16_f32 v36, v72, v73
    v_cvt_pk_f16_f32 v37, v74, v75
    v_cvt_pk_f16_f32 v38, v76, v77
    v_cvt_pk_f16_f32 v39, v78, v79
    v_med3_f32 v80, v80, v29, s65
    v_med3_f32 v81, v81, v29, s65
    v_med3_f32 v82, v82, v29, s65
    v_med3_f32 v83, v83, v29, s65
    v_med3_f32 v84, v84, v29, s65
    v_med3_f32 v85, v85, v29, s65
    v_med3_f32 v86, v86, v29, s65
    v_med3_f32 v87, v87, v29, s65
    v_med3_f32 v88, v88, v29, s65
    v_med3_f32 v89, v89, v29, s65
    v_med3_f32 v90, v90, v29, s65
    v_med3_f32 v91, v91, v29, s65
    v_med3_f32 v92, v92, v29, s65
    v_med3_f32 v93, v93, v29, s65
    v_med3_f32 v94, v94, v29, s65
    v_med3_f32 v95, v95, v29, s65
    v_cvt_pk_bf16_f32 v40, v80, v81
    v_cvt_pk_bf16_f32 v41, v82, v83
    v_cvt_pk_bf16_f32 v42, v84, v85
    v_cvt_pk_bf16_f32 v43, v86, v87
    v_cvt_pk_bf16_f32 v44, v88, v89
    v_cvt_pk_bf16_f32 v45, v90, v91
    v_cvt_pk_bf16_f32 v46, v92, v93
    v_cvt_pk_bf16_f32 v47, v94, v95
    ds_write_b128 v24, v[32:35]
    ds_write_b128 v25, v[36:39]
    ds_write_b128 v26, v[40:43]
    ds_write_b128 v27, v[44:47]
    ds_read_b128 v[64:67], v28 offset:0
    ds_read_b128 v[68:71], v28 offset:1024
    ds_read_b128 v[72:75], v28 offset:2048
    ds_read_b128 v[76:79], v28 offset:3072
    s_waitcnt lgkmcnt(3)
    buffer_store_dwordx4 v[64:67], v8, s[36:39], 0 offen offset:128 sc1
    s_waitcnt lgkmcnt(2)
    buffer_store_dwordx4 v[68:71], v9, s[36:39], 0 offen offset:128 sc1
    s_waitcnt lgkmcnt(1)
    buffer_store_dwordx4 v[72:75], v10, s[36:39], 0 offen offset:128 sc1
    s_waitcnt lgkmcnt(0)
    buffer_store_dwordx4 v[76:79], v11, s[36:39], 0 offen offset:128 sc1
    s_waitcnt vmcnt(0) lgkmcnt(0)
    s_barrier
    s_add_u32 s74, s74, 1
    s_cmp_lt_u32 s74, 256
    s_cbranch_scc1 K_HJOB
    ds_read_b64 v[12:13], v7 offset:0
    s_branch K_GO
.section .rodata,"a"
.p2align 6
.amdhsa_kernel standalone__edge_featured_mpnn_egc__graph_kernel
  .amdhsa_next_free_vgpr 256
  .amdhsa_next_free_sgpr 102
  .amdhsa_accum_offset 256
  .amdhsa_group_segment_fixed_size 0
  .amdhsa_fp16_overflow 1
  .amdhsa_kernarg_size 80
  .amdhsa_user_sgpr_count 2
  .amdhsa_user_sgpr_kernarg_segment_ptr 1
  .amdhsa_system_sgpr_workgroup_id_x 1
.end_amdhsa_kernel
```
